```python
import torch

def _softmax(x, axis=-1):
    return torch.softmax(x, dim=axis)
def _gelu(x):
    return torch.nn.functional.gelu(x, approximate="tanh")
def _silu(x):
    return torch.nn.functional.silu(x)
def _sigmoid(x):
    return torch.sigmoid(x)
def _layernorm(x, axis=-1, eps=1e-5):
    m = x.mean(dim=axis, keepdim=True)
    v = x.var(dim=axis, keepdim=True, unbiased=False)
    return (x - m) / torch.sqrt(v + eps)
def _scatter_add(tgt, idx, src, axis=0):
    return tgt.clone().index_add_(axis, idx, src)
def _segment_sum(src, seg, n):
    out = torch.zeros((n,) + src.shape[1:], dtype=src.dtype)
    return out.index_add_(0, seg, src)
def _pad(x, pw):
    flat = tuple(v for pair in reversed(pw) for v in pair)
    return torch.nn.functional.pad(x, flat)

kernel_name = 'parallel_sum__sliding_block_cached__mixer_channel_mlp__decode'

def setup_inputs():

    _w = (lambda a: (lambda t: t.to(torch.bfloat16) if t.is_floating_point() else t)(torch.as_tensor(a)))
    def _A_setup():
        B, Sq, D = 1, 1, 640
        Hq, Hkv, Sk, Dh = 32, 32, 4096, 128
        assert Hq % Hkv == 0, (Hq, Hkv)
        return {
            "x": _w((lambda *s: torch.randn(*s, dtype=torch.bfloat16) * 0.05)(B, Sq, D)),
            "k_cache": _w((lambda *s: torch.randn(*s, dtype=torch.bfloat16) * 3.2)(B, Hkv, Sk, Dh)),
            "v_cache": _w((lambda *s: torch.randn(*s, dtype=torch.bfloat16) * 0.4)(B, Hkv, Sk, Dh)),
            "wq": _w((lambda *s: torch.randn(*s, dtype=torch.bfloat16) * 3.2)(D, Hq * Dh) * (D ** -0.5)),
            "wo": _w((lambda *s: torch.randn(*s, dtype=torch.bfloat16) * 0.4)(Hq * Dh, D) * ((Hq * Dh) ** -0.5)),
        }
    _A_in = _A_setup()

    def _B_setup():
        B, S, D, F = 1, 1, 640, 1728
        return {
            "x": _w((lambda *s: torch.randn(*s, dtype=torch.bfloat16) * 0.05)(B, S, D)),
            "w1": _w((lambda *s: torch.randn(*s, dtype=torch.bfloat16) * 3.2)(D, F) * (D ** -0.5)),
            "b1": _w((lambda *s: torch.randn(*s, dtype=torch.bfloat16) * 0.8)(F)),
            "w2": _w((lambda *s: torch.randn(*s, dtype=torch.bfloat16) * 0.1)(F, D) * (F ** -0.5)),
            "b2": _w((lambda *s: torch.randn(*s, dtype=torch.bfloat16) * 0.1)(D)),
        }
    _B_in = _B_setup()

    return {
        "A_x": _A_in["x"],
        "A_k_cache": _A_in["k_cache"],
        "A_v_cache": _A_in["v_cache"],
        "A_wq": _A_in["wq"],
        "A_wo": _A_in["wo"],
        "B_x": _B_in["x"],
        "B_w1": _B_in["w1"],
        "B_b1": _B_in["b1"],
        "B_w2": _B_in["w2"],
        "B_b2": _B_in["b2"],
    }

def reference(A_x, A_k_cache, A_v_cache, A_wq, A_wo, B_x, B_w1, B_b1, B_w2, B_b2):
    def _A_ref(x, k_cache, v_cache, wq, wo):
        B, Sq, D = x.shape
        Hq, Dh = 32, 128
        Hkv, Sk = k_cache.shape[1], k_cache.shape[2]
        W = min(4096, max(256, Sk // 4))
        rep = Hq // Hkv
        q = (lambda x, *d: x.permute(*d))((x @ wq).reshape(B, Sq, Hq, Dh), 0, 2, 1, 3)
        k = (lambda x, n, axis: torch.repeat_interleave(x, n, dim=axis))(k_cache[:, :, Sk - W:, :], rep, axis=1)
        v = (lambda x, n, axis: torch.repeat_interleave(x, n, dim=axis))(v_cache[:, :, Sk - W:, :], rep, axis=1)
        scores = torch.einsum("bhqd,bhkd->bhqk", q, k) * (Dh ** -0.5)
        p = _softmax(scores, axis=-1)
        o = torch.einsum("bhqk,bhkd->bhqd", p, v)
        return (lambda x, *d: x.permute(*d))(o, 0, 2, 1, 3).reshape(B, Sq, Hq * Dh) @ wo

    def _B_ref(x, w1, b1, w2, b2):
        y = _layernorm(x, axis=-1)
        h = _gelu(torch.einsum("bsd,df->bsf", y, w1) + b1)
        return torch.einsum("bsf,fd->bsd", h, w2) + b2

    x = A_x
    xn = _layernorm(x, axis=-1)
    return x + _A_ref(xn, A_k_cache, A_v_cache, A_wq, A_wo) + _B_ref(xn, B_w1, B_b1, B_w2, B_b2)
```

```asm
; @launch grid=(256,1,1) block=(640,1,1) lds=141312
.amdgcn_target "amdgcn-amd-amdhsa--gfx950"
.text
.globl parallel_sum__sliding_block_cached__mixer_channel_mlp__decode_kernel
.p2align 8
.type parallel_sum__sliding_block_cached__mixer_channel_mlp__decode_kernel,@function
parallel_sum__sliding_block_cached__mixer_channel_mlp__decode_kernel:
    s_cmp_ge_u32 s2, 256
    s_cbranch_scc1 L_end
    s_load_dwordx16 s[16:31], s[0:1], 0
    s_load_dwordx8 s[32:39], s[0:1], 64
    s_load_dwordx2 s[40:41], s[0:1], 96
    v_lshrrev_b32 v2, 6, v0
    v_and_b32 v1, 63, v0
    s_and_b32 s4, s2, 31
    v_readfirstlane_b32 s3, v2
    s_lshr_b32 s5, s2, 5
    v_lshlrev_b32 v3, 2, v1
    v_lshlrev_b32 v4, 4, v1
    v_lshlrev_b32 v5, 3, v1
    v_mov_b32 v6, 0
    v_mov_b32 v8, 1
    s_waitcnt lgkmcnt(0)
    s_cmp_eq_u32 s3, 8
    s_cbranch_scc1 L_comm
    s_cmp_eq_u32 s3, 9
    s_cbranch_scc1 L_loader
    s_mul_i32 s6, s5, 80
    s_add_u32 s6, s6, s3
    s_lshl_b32 s7, s6, 13
    s_lshl_b32 s12, s4, 8
    s_add_u32 s7, s7, s12
    global_load_dword v10, v3, s[16:17] offset:0
    global_load_dword v11, v3, s[16:17] offset:256
    global_load_dword v12, v3, s[16:17] offset:512
    global_load_dword v13, v3, s[16:17] offset:768
    global_load_dword v14, v3, s[16:17] offset:1024
    v_add_u32 v120, s7, v3
    global_load_dword v54, v120, s[22:23] nt
    v_add_u32 v120, 0x10000, v120
    global_load_dword v55, v120, s[22:23] nt
    v_add_u32 v120, 0x10000, v120
    global_load_dword v56, v120, s[22:23] nt
    v_add_u32 v120, 0x10000, v120
    global_load_dword v57, v120, s[22:23] nt
    v_add_u32 v120, 0x10000, v120
    global_load_dword v58, v120, s[22:23] nt
    v_add_u32 v120, 0x10000, v120
    global_load_dword v59, v120, s[22:23] nt
    v_add_u32 v120, 0x10000, v120
    global_load_dword v60, v120, s[22:23] nt
    v_add_u32 v120, 0x10000, v120
    global_load_dword v61, v120, s[22:23] nt
    v_add_u32 v120, 0x10000, v120
    global_load_dword v62, v120, s[22:23] nt
    v_add_u32 v120, 0x10000, v120
    global_load_dword v63, v120, s[22:23] nt
    s_and_b32 s42, s2, 7
    s_lshr_b32 s43, s2, 3
    s_lshr_b32 s44, s43, 3
    s_lshl_b32 s44, s44, 3
    s_add_u32 s42, s42, s44
    s_and_b32 s43, s43, 7
    s_cmp_lt_u32 s42, 27
    s_cselect_b32 s45, 1, 0
    s_lshl_b32 s42, s42, 3
    s_add_u32 s42, s42, s43
    s_cmp_eq_u32 s45, 1
    s_cselect_b32 s42, s42, 0
    s_lshl_b32 s12, s42, 3
    s_add_u32 s12, s12, s3
    s_lshl_b32 s14, s12, 1
    v_mov_b32 v124, s14
    global_load_ushort v101, v124, s[30:31]
    global_load_dword v118, v6, s[40:41] sc1
    s_barrier
    s_waitcnt vmcnt(12)
    v_lshlrev_b32 v16, 16, v10
    v_and_b32 v17, 0xffff0000, v10
    v_lshlrev_b32 v18, 16, v11
    v_and_b32 v19, 0xffff0000, v11
    v_lshlrev_b32 v20, 16, v12
    v_and_b32 v21, 0xffff0000, v12
    v_lshlrev_b32 v22, 16, v13
    v_and_b32 v23, 0xffff0000, v13
    v_lshlrev_b32 v24, 16, v14
    v_and_b32 v25, 0xffff0000, v14
    v_add_f32 v46, v16, v17
    v_add_f32 v46, v18, v46
    v_add_f32 v46, v19, v46
    v_add_f32 v46, v20, v46
    v_add_f32 v46, v21, v46
    v_add_f32 v46, v22, v46
    v_add_f32 v46, v23, v46
    v_add_f32 v46, v24, v46
    v_add_f32 v46, v25, v46
    s_nop 1
    v_add_f32_dpp v46, v46, v46 quad_perm:[1,0,3,2] row_mask:0xf bank_mask:0xf
    s_nop 1
    v_add_f32_dpp v46, v46, v46 quad_perm:[2,3,0,1] row_mask:0xf bank_mask:0xf
    s_nop 1
    v_add_f32_dpp v46, v46, v46 row_half_mirror row_mask:0xf bank_mask:0xf
    s_nop 1
    v_add_f32_dpp v46, v46, v46 row_mirror row_mask:0xf bank_mask:0xf
    s_nop 0
    v_readlane_b32 s8, v46, 0
    v_readlane_b32 s9, v46, 16
    v_readlane_b32 s10, v46, 32
    v_readlane_b32 s11, v46, 48
    s_nop 1
    v_mov_b32 v46, s8
    v_add_f32 v46, s9, v46
    v_add_f32 v46, s10, v46
    v_add_f32 v46, s11, v46
    v_mul_f32 v47, 0x3acccccd, v46
    v_sub_f32 v52, v16, v47
    v_mul_f32 v48, v52, v52
    v_sub_f32 v52, v17, v47
    v_fmac_f32 v48, v52, v52
    v_sub_f32 v52, v18, v47
    v_fmac_f32 v48, v52, v52
    v_sub_f32 v52, v19, v47
    v_fmac_f32 v48, v52, v52
    v_sub_f32 v52, v20, v47
    v_fmac_f32 v48, v52, v52
    v_sub_f32 v52, v21, v47
    v_fmac_f32 v48, v52, v52
    v_sub_f32 v52, v22, v47
    v_fmac_f32 v48, v52, v52
    v_sub_f32 v52, v23, v47
    v_fmac_f32 v48, v52, v52
    v_sub_f32 v52, v24, v47
    v_fmac_f32 v48, v52, v52
    v_sub_f32 v52, v25, v47
    v_fmac_f32 v48, v52, v52
    s_nop 1
    v_add_f32_dpp v48, v48, v48 quad_perm:[1,0,3,2] row_mask:0xf bank_mask:0xf
    s_nop 1
    v_add_f32_dpp v48, v48, v48 quad_perm:[2,3,0,1] row_mask:0xf bank_mask:0xf
    s_nop 1
    v_add_f32_dpp v48, v48, v48 row_half_mirror row_mask:0xf bank_mask:0xf
    s_nop 1
    v_add_f32_dpp v48, v48, v48 row_mirror row_mask:0xf bank_mask:0xf
    s_nop 0
    v_readlane_b32 s8, v48, 0
    v_readlane_b32 s9, v48, 16
    v_readlane_b32 s10, v48, 32
    v_readlane_b32 s11, v48, 48
    s_nop 1
    v_mov_b32 v48, s8
    v_add_f32 v48, s9, v48
    v_add_f32 v48, s10, v48
    v_add_f32 v48, s11, v48
    v_mul_f32 v48, 0x3acccccd, v48
    v_cvt_pk_bf16_f32 v49, v47, v48
    v_lshlrev_b32 v50, 16, v49
    v_and_b32 v48, 0xffff0000, v49
    v_add_f32 v48, 0x3727c5ac, v48
    v_cvt_pk_bf16_f32 v49, v48, v48
    v_and_b32 v48, 0xffff0000, v49
    v_sqrt_f32 v48, v48
    s_nop 0
    v_cvt_pk_bf16_f32 v49, v48, v48
    v_and_b32 v48, 0xffff0000, v49
    v_rcp_f32 v51, v48
    v_sub_f32 v26, v16, v50
    v_sub_f32 v27, v17, v50
    v_cvt_pk_bf16_f32 v49, v26, v27
    v_lshlrev_b32 v26, 16, v49
    v_and_b32 v27, 0xffff0000, v49
    v_mul_f32 v26, v26, v51
    v_mul_f32 v27, v27, v51
    v_cvt_pk_bf16_f32 v49, v26, v27
    v_lshlrev_b32 v26, 16, v49
    v_and_b32 v27, 0xffff0000, v49
    v_sub_f32 v28, v18, v50
    v_sub_f32 v29, v19, v50
    v_cvt_pk_bf16_f32 v49, v28, v29
    v_lshlrev_b32 v28, 16, v49
    v_and_b32 v29, 0xffff0000, v49
    v_mul_f32 v28, v28, v51
    v_mul_f32 v29, v29, v51
    v_cvt_pk_bf16_f32 v49, v28, v29
    v_lshlrev_b32 v28, 16, v49
    v_and_b32 v29, 0xffff0000, v49
    v_sub_f32 v30, v20, v50
    v_sub_f32 v31, v21, v50
    v_cvt_pk_bf16_f32 v49, v30, v31
    v_lshlrev_b32 v30, 16, v49
    v_and_b32 v31, 0xffff0000, v49
    v_mul_f32 v30, v30, v51
    v_mul_f32 v31, v31, v51
    v_cvt_pk_bf16_f32 v49, v30, v31
    v_lshlrev_b32 v30, 16, v49
    v_and_b32 v31, 0xffff0000, v49
    v_sub_f32 v32, v22, v50
    v_sub_f32 v33, v23, v50
    v_cvt_pk_bf16_f32 v49, v32, v33
    v_lshlrev_b32 v32, 16, v49
    v_and_b32 v33, 0xffff0000, v49
    v_mul_f32 v32, v32, v51
    v_mul_f32 v33, v33, v51
    v_cvt_pk_bf16_f32 v49, v32, v33
    v_lshlrev_b32 v32, 16, v49
    v_and_b32 v33, 0xffff0000, v49
    v_sub_f32 v34, v24, v50
    v_sub_f32 v35, v25, v50
    v_cvt_pk_bf16_f32 v49, v34, v35
    v_lshlrev_b32 v34, 16, v49
    v_and_b32 v35, 0xffff0000, v49
    v_mul_f32 v34, v34, v51
    v_mul_f32 v35, v35, v51
    v_cvt_pk_bf16_f32 v49, v34, v35
    v_lshlrev_b32 v34, 16, v49
    v_and_b32 v35, 0xffff0000, v49
    ds_write_b64 v5, v[26:27] offset:0
    ds_write_b64 v5, v[28:29] offset:512
    ds_write_b64 v5, v[30:31] offset:1024
    ds_write_b64 v5, v[32:33] offset:1536
    ds_write_b64 v5, v[34:35] offset:2048
    s_lshl_b32 s12, s6, 2
    v_mov_b32 v122, s12
    s_waitcnt lgkmcnt(0)
    ds_read_b32 v16, v122 offset:0
    ds_read_b32 v17, v122 offset:32
    ds_read_b32 v18, v122 offset:64
    ds_read_b32 v19, v122 offset:96
    ds_read_b32 v20, v122 offset:128
    ds_read_b32 v21, v122 offset:160
    ds_read_b32 v22, v122 offset:192
    ds_read_b32 v23, v122 offset:224
    ds_read_b32 v24, v122 offset:256
    ds_read_b32 v25, v122 offset:288
    s_waitcnt vmcnt(2) lgkmcnt(0)
    v_lshlrev_b32 v48, 16, v54
    v_and_b32 v49, 0xffff0000, v54
    v_mul_f32 v46, v16, v48
    v_mul_f32 v47, v16, v49
    v_lshlrev_b32 v48, 16, v55
    v_and_b32 v49, 0xffff0000, v55
    v_fmac_f32 v46, v17, v48
    v_fmac_f32 v47, v17, v49
    v_lshlrev_b32 v48, 16, v56
    v_and_b32 v49, 0xffff0000, v56
    v_fmac_f32 v46, v18, v48
    v_fmac_f32 v47, v18, v49
    v_lshlrev_b32 v48, 16, v57
    v_and_b32 v49, 0xffff0000, v57
    v_fmac_f32 v46, v19, v48
    v_fmac_f32 v47, v19, v49
    v_lshlrev_b32 v48, 16, v58
    v_and_b32 v49, 0xffff0000, v58
    v_fmac_f32 v46, v20, v48
    v_fmac_f32 v47, v20, v49
    v_lshlrev_b32 v48, 16, v59
    v_and_b32 v49, 0xffff0000, v59
    v_fmac_f32 v46, v21, v48
    v_fmac_f32 v47, v21, v49
    v_lshlrev_b32 v48, 16, v60
    v_and_b32 v49, 0xffff0000, v60
    v_fmac_f32 v46, v22, v48
    v_fmac_f32 v47, v22, v49
    v_lshlrev_b32 v48, 16, v61
    v_and_b32 v49, 0xffff0000, v61
    v_fmac_f32 v46, v23, v48
    v_fmac_f32 v47, v23, v49
    v_lshlrev_b32 v48, 16, v62
    v_and_b32 v49, 0xffff0000, v62
    v_fmac_f32 v46, v24, v48
    v_fmac_f32 v47, v24, v49
    v_lshlrev_b32 v48, 16, v63
    v_and_b32 v49, 0xffff0000, v63
    v_fmac_f32 v46, v25, v48
    v_fmac_f32 v47, v25, v49
    s_lshl_b32 s12, s3, 9
    v_add_u32 v122, s12, v5
    ds_write_b64 v122, v[46:47] offset:5120
    s_waitcnt lgkmcnt(0)
    s_mov_b64 exec, 1
    ds_add_u32 v6, v8 offset:13952
    s_mov_b64 exec, -1
    v_add_f32 v46, v26, v27
    v_add_f32 v46, v28, v46
    v_add_f32 v46, v29, v46
    v_add_f32 v46, v30, v46
    v_add_f32 v46, v31, v46
    v_add_f32 v46, v32, v46
    v_add_f32 v46, v33, v46
    v_add_f32 v46, v34, v46
    v_add_f32 v46, v35, v46
    s_nop 1
    v_add_f32_dpp v46, v46, v46 quad_perm:[1,0,3,2] row_mask:0xf bank_mask:0xf
    s_nop 1
    v_add_f32_dpp v46, v46, v46 quad_perm:[2,3,0,1] row_mask:0xf bank_mask:0xf
    s_nop 1
    v_add_f32_dpp v46, v46, v46 row_half_mirror row_mask:0xf bank_mask:0xf
    s_nop 1
    v_add_f32_dpp v46, v46, v46 row_mirror row_mask:0xf bank_mask:0xf
    s_nop 0
    v_readlane_b32 s8, v46, 0
    v_readlane_b32 s9, v46, 16
    v_readlane_b32 s10, v46, 32
    v_readlane_b32 s11, v46, 48
    s_nop 1
    v_mov_b32 v46, s8
    v_add_f32 v46, s9, v46
    v_add_f32 v46, s10, v46
    v_add_f32 v46, s11, v46
    v_mul_f32 v47, 0x3acccccd, v46
    v_sub_f32 v52, v26, v47
    v_mul_f32 v48, v52, v52
    v_sub_f32 v52, v27, v47
    v_fmac_f32 v48, v52, v52
    v_sub_f32 v52, v28, v47
    v_fmac_f32 v48, v52, v52
    v_sub_f32 v52, v29, v47
    v_fmac_f32 v48, v52, v52
    v_sub_f32 v52, v30, v47
    v_fmac_f32 v48, v52, v52
    v_sub_f32 v52, v31, v47
    v_fmac_f32 v48, v52, v52
    v_sub_f32 v52, v32, v47
    v_fmac_f32 v48, v52, v52
    v_sub_f32 v52, v33, v47
    v_fmac_f32 v48, v52, v52
    v_sub_f32 v52, v34, v47
    v_fmac_f32 v48, v52, v52
    v_sub_f32 v52, v35, v47
    v_fmac_f32 v48, v52, v52
    s_nop 1
    v_add_f32_dpp v48, v48, v48 quad_perm:[1,0,3,2] row_mask:0xf bank_mask:0xf
    s_nop 1
    v_add_f32_dpp v48, v48, v48 quad_perm:[2,3,0,1] row_mask:0xf bank_mask:0xf
    s_nop 1
    v_add_f32_dpp v48, v48, v48 row_half_mirror row_mask:0xf bank_mask:0xf
    s_nop 1
    v_add_f32_dpp v48, v48, v48 row_mirror row_mask:0xf bank_mask:0xf
    s_nop 0
    v_readlane_b32 s8, v48, 0
    v_readlane_b32 s9, v48, 16
    v_readlane_b32 s10, v48, 32
    v_readlane_b32 s11, v48, 48
    s_nop 1
    v_mov_b32 v48, s8
    v_add_f32 v48, s9, v48
    v_add_f32 v48, s10, v48
    v_add_f32 v48, s11, v48
    v_mul_f32 v48, 0x3acccccd, v48
    v_cvt_pk_bf16_f32 v49, v47, v48
    v_lshlrev_b32 v50, 16, v49
    v_and_b32 v48, 0xffff0000, v49
    v_add_f32 v48, 0x3727c5ac, v48
    v_cvt_pk_bf16_f32 v49, v48, v48
    v_and_b32 v48, 0xffff0000, v49
    v_sqrt_f32 v48, v48
    s_nop 0
    v_cvt_pk_bf16_f32 v49, v48, v48
    v_and_b32 v48, 0xffff0000, v49
    v_rcp_f32 v51, v48
    v_sub_f32 v36, v26, v50
    v_sub_f32 v37, v27, v50
    v_cvt_pk_bf16_f32 v49, v36, v37
    v_lshlrev_b32 v36, 16, v49
    v_and_b32 v37, 0xffff0000, v49
    v_mul_f32 v36, v36, v51
    v_mul_f32 v37, v37, v51
    v_cvt_pk_bf16_f32 v49, v36, v37
    v_lshlrev_b32 v36, 16, v49
    v_and_b32 v37, 0xffff0000, v49
    v_sub_f32 v38, v28, v50
    v_sub_f32 v39, v29, v50
    v_cvt_pk_bf16_f32 v49, v38, v39
    v_lshlrev_b32 v38, 16, v49
    v_and_b32 v39, 0xffff0000, v49
    v_mul_f32 v38, v38, v51
    v_mul_f32 v39, v39, v51
    v_cvt_pk_bf16_f32 v49, v38, v39
    v_lshlrev_b32 v38, 16, v49
    v_and_b32 v39, 0xffff0000, v49
    v_sub_f32 v40, v30, v50
    v_sub_f32 v41, v31, v50
    v_cvt_pk_bf16_f32 v49, v40, v41
    v_lshlrev_b32 v40, 16, v49
    v_and_b32 v41, 0xffff0000, v49
    v_mul_f32 v40, v40, v51
    v_mul_f32 v41, v41, v51
    v_cvt_pk_bf16_f32 v49, v40, v41
    v_lshlrev_b32 v40, 16, v49
    v_and_b32 v41, 0xffff0000, v49
    v_sub_f32 v42, v32, v50
    v_sub_f32 v43, v33, v50
    v_cvt_pk_bf16_f32 v49, v42, v43
    v_lshlrev_b32 v42, 16, v49
    v_and_b32 v43, 0xffff0000, v49
    v_mul_f32 v42, v42, v51
    v_mul_f32 v43, v43, v51
    v_cvt_pk_bf16_f32 v49, v42, v43
    v_lshlrev_b32 v42, 16, v49
    v_and_b32 v43, 0xffff0000, v49
    v_sub_f32 v44, v34, v50
    v_sub_f32 v45, v35, v50
    v_cvt_pk_bf16_f32 v49, v44, v45
    v_lshlrev_b32 v44, 16, v49
    v_and_b32 v45, 0xffff0000, v49
    v_mul_f32 v44, v44, v51
    v_mul_f32 v45, v45, v51
    v_cvt_pk_bf16_f32 v49, v44, v45
    v_lshlrev_b32 v44, 16, v49
    v_and_b32 v45, 0xffff0000, v49
    ds_write_b64 v5, v[36:37] offset:2560
    ds_write_b64 v5, v[38:39] offset:3072
    ds_write_b64 v5, v[40:41] offset:3584
    ds_write_b64 v5, v[42:43] offset:4096
    ds_write_b64 v5, v[44:45] offset:4608
L_lw0:
    ds_read_b32 v7, v6 offset:13956
    s_waitcnt lgkmcnt(0)
    v_readfirstlane_b32 s12, v7
    s_cmp_ge_u32 s12, 1
    s_cbranch_scc1 L_lw0_d
    s_sleep 1
    s_branch L_lw0
L_lw0_d:
    v_and_b32 v124, 15, v1
    v_lshlrev_b32 v124, 4, v124
    ds_read_b128 v[46:49], v124 offset:9216
    s_lshl_b32 s14, s3, 2
    s_add_u32 s14, s14, 4
L_lw1:
    ds_read_b32 v7, v6 offset:13972
    s_waitcnt lgkmcnt(0)
    v_readfirstlane_b32 s12, v7
    s_cmp_ge_u32 s12, s14
    s_cbranch_scc1 L_lw1_d
    s_sleep 1
    s_branch L_lw1
L_lw1_d:
    s_lshl_b32 s12, s3, 12
    v_add_u32 v124, s12, v4
    ds_read_b128 v[64:67], v124 offset:34816
    ds_read_b128 v[68:71], v124 offset:35840
    ds_read_b128 v[72:75], v124 offset:36864
    ds_read_b128 v[76:79], v124 offset:37888
    s_waitcnt lgkmcnt(0)
    v_dot2_f32_bf16 v16, v64, v46, 0
    v_dot2_f32_bf16 v17, v68, v46, 0
    v_dot2_f32_bf16 v18, v72, v46, 0
    v_dot2_f32_bf16 v19, v76, v46, 0
    v_dot2_f32_bf16 v16, v65, v47, v16
    v_dot2_f32_bf16 v17, v69, v47, v17
    v_dot2_f32_bf16 v18, v73, v47, v18
    v_dot2_f32_bf16 v19, v77, v47, v19
    v_dot2_f32_bf16 v16, v66, v48, v16
    v_dot2_f32_bf16 v17, v70, v48, v17
    v_dot2_f32_bf16 v18, v74, v48, v18
    v_dot2_f32_bf16 v19, v78, v48, v19
    v_dot2_f32_bf16 v16, v67, v49, v16
    v_dot2_f32_bf16 v17, v71, v49, v17
    v_dot2_f32_bf16 v18, v75, v49, v18
    v_dot2_f32_bf16 v19, v79, v49, v19
    s_nop 2
    v_add_f32_dpp v16, v16, v16 quad_perm:[1,0,3,2] row_mask:0xf bank_mask:0xf
    v_add_f32_dpp v17, v17, v17 quad_perm:[1,0,3,2] row_mask:0xf bank_mask:0xf
    v_add_f32_dpp v18, v18, v18 quad_perm:[1,0,3,2] row_mask:0xf bank_mask:0xf
    v_add_f32_dpp v19, v19, v19 quad_perm:[1,0,3,2] row_mask:0xf bank_mask:0xf
    v_add_f32_dpp v16, v16, v16 quad_perm:[2,3,0,1] row_mask:0xf bank_mask:0xf
    v_add_f32_dpp v17, v17, v17 quad_perm:[2,3,0,1] row_mask:0xf bank_mask:0xf
    v_add_f32_dpp v18, v18, v18 quad_perm:[2,3,0,1] row_mask:0xf bank_mask:0xf
    v_add_f32_dpp v19, v19, v19 quad_perm:[2,3,0,1] row_mask:0xf bank_mask:0xf
    v_add_f32_dpp v16, v16, v16 row_half_mirror row_mask:0xf bank_mask:0xf
    v_add_f32_dpp v17, v17, v17 row_half_mirror row_mask:0xf bank_mask:0xf
    v_add_f32_dpp v18, v18, v18 row_half_mirror row_mask:0xf bank_mask:0xf
    v_add_f32_dpp v19, v19, v19 row_half_mirror row_mask:0xf bank_mask:0xf
    v_add_f32_dpp v16, v16, v16 row_mirror row_mask:0xf bank_mask:0xf
    v_add_f32_dpp v17, v17, v17 row_mirror row_mask:0xf bank_mask:0xf
    v_add_f32_dpp v18, v18, v18 row_mirror row_mask:0xf bank_mask:0xf
    v_add_f32_dpp v19, v19, v19 row_mirror row_mask:0xf bank_mask:0xf
    v_cvt_pk_bf16_f32 v20, v16, v17
    v_cvt_pk_bf16_f32 v21, v18, v19
    v_lshlrev_b32 v16, 16, v20
    v_and_b32 v17, 0xffff0000, v20
    v_lshlrev_b32 v18, 16, v21
    v_and_b32 v19, 0xffff0000, v21
    v_mul_f32 v16, 0x3db504f3, v16
    v_mul_f32 v17, 0x3db504f3, v17
    v_mul_f32 v18, 0x3db504f3, v18
    v_mul_f32 v19, 0x3db504f3, v19
    v_cvt_pk_bf16_f32 v20, v16, v17
    v_cvt_pk_bf16_f32 v21, v18, v19
    v_lshlrev_b32 v16, 16, v20
    v_and_b32 v17, 0xffff0000, v20
    v_lshlrev_b32 v18, 16, v21
    v_and_b32 v19, 0xffff0000, v21
    v_max3_f32 v22, v16, v17, v18
    v_max_f32 v22, v22, v19
    s_nop 0
    v_readlane_b32 s8, v22, 0
    v_readlane_b32 s9, v22, 16
    v_readlane_b32 s10, v22, 32
    v_readlane_b32 s11, v22, 48
    s_nop 1
    v_mov_b32 v22, s8
    v_max_f32 v22, s9, v22
    v_max_f32 v22, s10, v22
    v_max_f32 v22, s11, v22
    v_sub_f32 v24, v16, v22
    v_mul_f32 v24, 0x3fb8aa3b, v24
    v_exp_f32 v24, v24
    v_sub_f32 v25, v17, v22
    v_mul_f32 v25, 0x3fb8aa3b, v25
    v_exp_f32 v25, v25
    v_sub_f32 v26, v18, v22
    v_mul_f32 v26, 0x3fb8aa3b, v26
    v_exp_f32 v26, v26
    v_sub_f32 v27, v19, v22
    v_mul_f32 v27, 0x3fb8aa3b, v27
    v_exp_f32 v27, v27
    s_nop 0
    v_add_f32 v23, v24, v25
    v_add_f32 v23, v26, v23
    v_add_f32 v23, v27, v23
    s_nop 0
    v_readlane_b32 s8, v23, 0
    v_readlane_b32 s9, v23, 16
    v_readlane_b32 s10, v23, 32
    v_readlane_b32 s11, v23, 48
    v_readlane_b32 s48, v24, 0
    v_readlane_b32 s49, v24, 16
    v_readlane_b32 s50, v24, 32
    v_readlane_b32 s51, v24, 48
    v_readlane_b32 s52, v25, 0
    v_readlane_b32 s53, v25, 16
    v_readlane_b32 s54, v25, 32
    v_readlane_b32 s55, v25, 48
    v_readlane_b32 s56, v26, 0
    v_readlane_b32 s57, v26, 16
    v_readlane_b32 s58, v26, 32
    v_readlane_b32 s59, v26, 48
    v_readlane_b32 s60, v27, 0
    v_readlane_b32 s61, v27, 16
    v_readlane_b32 s62, v27, 32
    v_readlane_b32 s63, v27, 48
    v_mov_b32 v23, s8
    v_add_f32 v23, s9, v23
    v_add_f32 v23, s10, v23
    v_add_f32 v23, s11, v23
    s_lshl_b32 s14, s3, 2
    s_add_u32 s14, s14, 36
L_lw2:
    ds_read_b32 v7, v6 offset:13972
    s_waitcnt lgkmcnt(0)
    v_readfirstlane_b32 s12, v7
    s_cmp_ge_u32 s12, s14
    s_cbranch_scc1 L_lw2_d
    s_sleep 1
    s_branch L_lw2
L_lw2_d:
    s_lshl_b32 s12, s3, 12
    s_add_u32 s12, s12, 67584
    v_add_u32 v124, s12, v3
    ds_read_b32 v80, v124 offset:0
    ds_read_b32 v81, v124 offset:256
    ds_read_b32 v82, v124 offset:512
    ds_read_b32 v83, v124 offset:768
    ds_read_b32 v84, v124 offset:1024
    ds_read_b32 v85, v124 offset:1280
    ds_read_b32 v86, v124 offset:1536
    ds_read_b32 v87, v124 offset:1792
    ds_read_b32 v88, v124 offset:2048
    ds_read_b32 v89, v124 offset:2304
    ds_read_b32 v90, v124 offset:2560
    ds_read_b32 v91, v124 offset:2816
    ds_read_b32 v92, v124 offset:3072
    ds_read_b32 v93, v124 offset:3328
    ds_read_b32 v94, v124 offset:3584
    ds_read_b32 v95, v124 offset:3840
    s_waitcnt lgkmcnt(12)
    v_lshlrev_b32 v48, 16, v80
    v_and_b32 v49, 0xffff0000, v80
    v_mul_f32 v28, s48, v48
    v_mul_f32 v29, s48, v49
    v_lshlrev_b32 v48, 16, v81
    v_and_b32 v49, 0xffff0000, v81
    v_fmac_f32 v28, s49, v48
    v_fmac_f32 v29, s49, v49
    v_lshlrev_b32 v48, 16, v82
    v_and_b32 v49, 0xffff0000, v82
    v_fmac_f32 v28, s50, v48
    v_fmac_f32 v29, s50, v49
    v_lshlrev_b32 v48, 16, v83
    v_and_b32 v49, 0xffff0000, v83
    v_fmac_f32 v28, s51, v48
    v_fmac_f32 v29, s51, v49
    s_waitcnt lgkmcnt(8)
    v_lshlrev_b32 v48, 16, v84
    v_and_b32 v49, 0xffff0000, v84
    v_fmac_f32 v28, s52, v48
    v_fmac_f32 v29, s52, v49
    v_lshlrev_b32 v48, 16, v85
    v_and_b32 v49, 0xffff0000, v85
    v_fmac_f32 v28, s53, v48
    v_fmac_f32 v29, s53, v49
    v_lshlrev_b32 v48, 16, v86
    v_and_b32 v49, 0xffff0000, v86
    v_fmac_f32 v28, s54, v48
    v_fmac_f32 v29, s54, v49
    v_lshlrev_b32 v48, 16, v87
    v_and_b32 v49, 0xffff0000, v87
    v_fmac_f32 v28, s55, v48
    v_fmac_f32 v29, s55, v49
    s_waitcnt lgkmcnt(4)
    v_lshlrev_b32 v48, 16, v88
    v_and_b32 v49, 0xffff0000, v88
    v_fmac_f32 v28, s56, v48
    v_fmac_f32 v29, s56, v49
    v_lshlrev_b32 v48, 16, v89
    v_and_b32 v49, 0xffff0000, v89
    v_fmac_f32 v28, s57, v48
    v_fmac_f32 v29, s57, v49
    v_lshlrev_b32 v48, 16, v90
    v_and_b32 v49, 0xffff0000, v90
    v_fmac_f32 v28, s58, v48
    v_fmac_f32 v29, s58, v49
    v_lshlrev_b32 v48, 16, v91
    v_and_b32 v49, 0xffff0000, v91
    v_fmac_f32 v28, s59, v48
    v_fmac_f32 v29, s59, v49
    s_waitcnt lgkmcnt(0)
    v_lshlrev_b32 v48, 16, v92
    v_and_b32 v49, 0xffff0000, v92
    v_fmac_f32 v28, s60, v48
    v_fmac_f32 v29, s60, v49
    v_lshlrev_b32 v48, 16, v93
    v_and_b32 v49, 0xffff0000, v93
    v_fmac_f32 v28, s61, v48
    v_fmac_f32 v29, s61, v49
    v_lshlrev_b32 v48, 16, v94
    v_and_b32 v49, 0xffff0000, v94
    v_fmac_f32 v28, s62, v48
    v_fmac_f32 v29, s62, v49
    v_lshlrev_b32 v48, 16, v95
    v_and_b32 v49, 0xffff0000, v95
    v_fmac_f32 v28, s63, v48
    v_fmac_f32 v29, s63, v49
    s_lshl_b32 s12, s3, 9
    v_add_u32 v124, s12, v5
    ds_write_b64 v124, v[28:29] offset:9472
    s_lshl_b32 s12, s3, 3
    v_mov_b32 v125, s12
    ds_write_b64 v125, v[22:23] offset:13568
    s_waitcnt lgkmcnt(0)
    s_mov_b64 exec, 1
    ds_add_u32 v6, v8 offset:13960
    s_mov_b64 exec, -1
L_lw3:
    ds_read_b32 v7, v6 offset:13972
    s_waitcnt lgkmcnt(0)
    v_readfirstlane_b32 s12, v7
    s_cmp_ge_u32 s12, 74
    s_cbranch_scc1 L_lw3_d
    s_sleep 1
    s_branch L_lw3
L_lw3_d:
    v_lshrrev_b32 v124, 2, v1
    v_lshlrev_b32 v124, 2, v124
    s_mul_i32 s14, s3, 320
    v_add_u32 v124, s14, v124
    ds_read_b32 v16, v124 offset:2560
    ds_read_b32 v17, v124 offset:2624
    ds_read_b32 v18, v124 offset:2688
    ds_read_b32 v19, v124 offset:2752
    ds_read_b32 v20, v124 offset:2816
    s_mul_i32 s14, s3, 1280
    s_add_u32 s14, s14, 100352
    v_add_u32 v125, s14, v3
    ds_read_b32 v96, v125 offset:0
    ds_read_b32 v97, v125 offset:256
    ds_read_b32 v98, v125 offset:512
    ds_read_b32 v99, v125 offset:768
    ds_read_b32 v100, v125 offset:1024
    s_waitcnt lgkmcnt(0)
    v_lshlrev_b32 v48, 16, v96
    v_and_b32 v49, 0xffff0000, v96
    v_mul_f32 v46, v16, v48
    v_mul_f32 v47, v16, v49
    v_lshlrev_b32 v48, 16, v97
    v_and_b32 v49, 0xffff0000, v97
    v_fmac_f32 v46, v17, v48
    v_fmac_f32 v47, v17, v49
    v_lshlrev_b32 v48, 16, v98
    v_and_b32 v49, 0xffff0000, v98
    v_fmac_f32 v46, v18, v48
    v_fmac_f32 v47, v18, v49
    v_lshlrev_b32 v48, 16, v99
    v_and_b32 v49, 0xffff0000, v99
    v_fmac_f32 v46, v19, v48
    v_fmac_f32 v47, v19, v49
    v_lshlrev_b32 v48, 16, v100
    v_and_b32 v49, 0xffff0000, v100
    v_fmac_f32 v46, v20, v48
    v_fmac_f32 v47, v20, v49
    s_nop 1
    v_add_f32_dpp v46, v46, v46 row_ror:4 row_mask:0xf bank_mask:0xf
    v_add_f32_dpp v47, v47, v47 row_ror:4 row_mask:0xf bank_mask:0xf
    s_nop 1
    v_add_f32_dpp v46, v46, v46 row_ror:8 row_mask:0xf bank_mask:0xf
    v_add_f32_dpp v47, v47, v47 row_ror:8 row_mask:0xf bank_mask:0xf
    v_xor_b32 v124, 16, v1
    v_lshlrev_b32 v124, 2, v124
    v_xor_b32 v123, 32, v1
    v_lshlrev_b32 v123, 2, v123
    ds_bpermute_b32 v48, v124, v46
    ds_bpermute_b32 v49, v124, v47
    s_waitcnt lgkmcnt(0)
    v_add_f32 v46, v46, v48
    v_add_f32 v47, v47, v49
    ds_bpermute_b32 v48, v123, v46
    ds_bpermute_b32 v49, v123, v47
    s_waitcnt lgkmcnt(0)
    v_add_f32 v46, v46, v48
    v_add_f32 v47, v47, v49
    v_and_b32 v124, 3, v1
    v_lshlrev_b32 v124, 3, v124
    s_lshl_b32 s14, s3, 5
    v_add_u32 v124, s14, v124
    ds_write_b64 v124, v[46:47] offset:13696
    s_waitcnt lgkmcnt(0)
    s_mov_b64 exec, 1
    ds_add_u32 v6, v8 offset:13968
    s_mov_b64 exec, -1
L_lw4:
    ds_read_b32 v7, v6 offset:13968
    s_waitcnt lgkmcnt(0)
    v_readfirstlane_b32 s12, v7
    s_cmp_ge_u32 s12, 8
    s_cbranch_scc1 L_lw4_d
    s_sleep 1
    s_branch L_lw4
L_lw4_d:
    s_lshl_b32 s12, s3, 2
    v_mov_b32 v124, s12
    ds_read_b32 v16, v124 offset:13696
    ds_read_b32 v17, v124 offset:13728
    ds_read_b32 v18, v124 offset:13760
    ds_read_b32 v19, v124 offset:13792
    ds_read_b32 v20, v124 offset:13824
    ds_read_b32 v21, v124 offset:13856
    ds_read_b32 v22, v124 offset:13888
    ds_read_b32 v23, v124 offset:13920
    s_waitcnt vmcnt(0) lgkmcnt(0)
    v_add_f32 v30, v16, v17
    v_add_f32 v30, v18, v30
    v_add_f32 v30, v19, v30
    v_add_f32 v30, v20, v30
    v_add_f32 v30, v21, v30
    v_add_f32 v30, v22, v30
    v_add_f32 v30, v23, v30
    v_cvt_pk_bf16_f32 v48, v30, v30
    v_and_b32 v30, 0xffff0000, v48
    v_lshlrev_b32 v49, 16, v101
    v_add_f32 v30, v30, v49
    v_cvt_pk_bf16_f32 v48, v30, v30
    v_and_b32 v30, 0xffff0000, v48
    v_mul_f32 v31, v30, v30
    v_mul_f32 v31, v31, v30
    v_mul_f32 v31, 0x3d372713, v31
    v_add_f32 v31, v30, v31
    v_mul_f32 v31, 0x3f4c422a, v31
    v_mul_f32 v31, 0x4038aa3b, v31
    v_exp_f32 v31, v31
    s_nop 0
    v_add_f32 v31, 1.0, v31
    v_rcp_f32 v31, v31
    s_nop 0
    v_fma_f32 v31, v31, -2.0, 1.0
    v_add_f32 v31, 1.0, v31
    v_mul_f32 v31, 0.5, v31
    v_mul_f32 v30, v30, v31
    v_cvt_pk_bf16_f32 v48, v30, v30
    v_and_b32 v30, 0xffff0000, v48
    v_cvt_f32_u32 v31, s45
    v_mul_f32 v30, v30, v31
L_lw5:
    ds_read_b32 v7, v6 offset:13972
    s_waitcnt lgkmcnt(0)
    v_readfirstlane_b32 s12, v7
    s_cmp_ge_u32 s12, 84
    s_cbranch_scc1 L_lw5_d
    s_sleep 1
    s_branch L_lw5
L_lw5_d:
    s_mul_i32 s14, s3, 1280
    s_add_u32 s14, s14, 110592
    v_add_u32 v125, s14, v3
    ds_read_b32 v102, v125 offset:0
    ds_read_b32 v103, v125 offset:256
    ds_read_b32 v104, v125 offset:512
    ds_read_b32 v105, v125 offset:768
    ds_read_b32 v106, v125 offset:1024
    s_waitcnt lgkmcnt(0)
    v_lshlrev_b32 v48, 16, v102
    v_and_b32 v49, 0xffff0000, v102
    v_mul_f32 v34, v30, v48
    v_mul_f32 v35, v30, v49
    v_lshlrev_b32 v48, 16, v103
    v_and_b32 v49, 0xffff0000, v103
    v_mul_f32 v36, v30, v48
    v_mul_f32 v37, v30, v49
    v_lshlrev_b32 v48, 16, v104
    v_and_b32 v49, 0xffff0000, v104
    v_mul_f32 v38, v30, v48
    v_mul_f32 v39, v30, v49
    v_lshlrev_b32 v48, 16, v105
    v_and_b32 v49, 0xffff0000, v105
    v_mul_f32 v40, v30, v48
    v_mul_f32 v41, v30, v49
    v_lshlrev_b32 v48, 16, v106
    v_and_b32 v49, 0xffff0000, v106
    v_mul_f32 v42, v30, v48
    v_mul_f32 v43, v30, v49
L_lw6:
    ds_read_b32 v7, v6 offset:13972
    s_waitcnt lgkmcnt(0)
    v_readfirstlane_b32 s12, v7
    s_cmp_ge_u32 s12, 104
    s_cbranch_scc1 L_lw6_d
    s_sleep 1
    s_branch L_lw6
L_lw6_d:
    ds_read_b32 v108, v125 offset:10240
    ds_read_b32 v113, v125 offset:20480
    ds_read_b32 v109, v125 offset:10496
    ds_read_b32 v114, v125 offset:20736
    ds_read_b32 v110, v125 offset:10752
    ds_read_b32 v115, v125 offset:20992
    ds_read_b32 v111, v125 offset:11008
    ds_read_b32 v116, v125 offset:21248
    ds_read_b32 v112, v125 offset:11264
    ds_read_b32 v117, v125 offset:21504
L_lw7:
    ds_read_b32 v7, v6 offset:13964
    s_waitcnt lgkmcnt(0)
    v_readfirstlane_b32 s12, v7
    s_cmp_ge_u32 s12, 1
    s_cbranch_scc1 L_lw7_d
    s_sleep 1
    s_branch L_lw7
L_lw7_d:
    s_lshl_b32 s12, s3, 2
    v_mov_b32 v124, s12
    ds_read_b32 v30, v124 offset:13632
    ds_read_b32 v31, v124 offset:13664
    s_waitcnt lgkmcnt(0)
    v_lshlrev_b32 v48, 16, v108
    v_and_b32 v49, 0xffff0000, v108
    v_fmac_f32 v34, v30, v48
    v_fmac_f32 v35, v30, v49
    v_lshlrev_b32 v48, 16, v109
    v_and_b32 v49, 0xffff0000, v109
    v_fmac_f32 v36, v30, v48
    v_fmac_f32 v37, v30, v49
    v_lshlrev_b32 v48, 16, v110
    v_and_b32 v49, 0xffff0000, v110
    v_fmac_f32 v38, v30, v48
    v_fmac_f32 v39, v30, v49
    v_lshlrev_b32 v48, 16, v111
    v_and_b32 v49, 0xffff0000, v111
    v_fmac_f32 v40, v30, v48
    v_fmac_f32 v41, v30, v49
    v_lshlrev_b32 v48, 16, v112
    v_and_b32 v49, 0xffff0000, v112
    v_fmac_f32 v42, v30, v48
    v_fmac_f32 v43, v30, v49
    v_lshlrev_b32 v48, 16, v113
    v_and_b32 v49, 0xffff0000, v113
    v_fmac_f32 v34, v31, v48
    v_fmac_f32 v35, v31, v49
    v_lshlrev_b32 v48, 16, v114
    v_and_b32 v49, 0xffff0000, v114
    v_fmac_f32 v36, v31, v48
    v_fmac_f32 v37, v31, v49
    v_lshlrev_b32 v48, 16, v115
    v_and_b32 v49, 0xffff0000, v115
    v_fmac_f32 v38, v31, v48
    v_fmac_f32 v39, v31, v49
    v_lshlrev_b32 v48, 16, v116
    v_and_b32 v49, 0xffff0000, v116
    v_fmac_f32 v40, v31, v48
    v_fmac_f32 v41, v31, v49
    v_lshlrev_b32 v48, 16, v117
    v_and_b32 v49, 0xffff0000, v117
    v_fmac_f32 v42, v31, v48
    v_fmac_f32 v43, v31, v49
    s_mul_i32 s12, s3, 2560
    v_add_u32 v124, s12, v5
    ds_write_b64 v124, v[34:35] offset:14080
    ds_write_b64 v124, v[36:37] offset:14592
    ds_write_b64 v124, v[38:39] offset:15104
    ds_write_b64 v124, v[40:41] offset:15616
    ds_write_b64 v124, v[42:43] offset:16128
    s_waitcnt lgkmcnt(0)
    s_mov_b64 exec, 1
    ds_add_u32 v6, v8 offset:13968
    s_mov_b64 exec, -1
    s_cmp_ge_u32 s3, 5
    s_cbranch_scc1 L_dflush
L_lw8:
    ds_read_b32 v7, v6 offset:13968
    s_waitcnt lgkmcnt(0)
    v_readfirstlane_b32 s12, v7
    s_cmp_ge_u32 s12, 16
    s_cbranch_scc1 L_lw8_d
    s_sleep 1
    s_branch L_lw8
L_lw8_d:
    s_lshl_b32 s12, s3, 9
    v_add_u32 v124, s12, v5
    ds_read_b64 v[64:65], v124 offset:14080
    ds_read_b64 v[66:67], v124 offset:16640
    ds_read_b64 v[68:69], v124 offset:19200
    ds_read_b64 v[70:71], v124 offset:21760
    ds_read_b64 v[72:73], v124 offset:24320
    ds_read_b64 v[74:75], v124 offset:26880
    ds_read_b64 v[76:77], v124 offset:29440
    ds_read_b64 v[78:79], v124 offset:32000
    s_lshl_b32 s12, s3, 6
    v_add_u32 v125, s12, v1
    v_lshrrev_b32 v123, 1, v125
    v_lshlrev_b32 v123, 13, v123
    v_and_b32 v125, 1, v125
    v_lshl_add_u32 v123, v125, 4, v123
    s_lshl_b32 s12, s2, 5
    s_add_u32 s12, s12, 1048576
    v_add_u32 v123, s12, v123
    s_waitcnt lgkmcnt(0)
    v_add_f32 v80, v64, v66
    v_add_f32 v82, v65, v67
    v_add_f32 v80, v68, v80
    v_add_f32 v82, v69, v82
    v_add_f32 v80, v70, v80
    v_add_f32 v82, v71, v82
    v_add_f32 v80, v72, v80
    v_add_f32 v82, v73, v82
    v_add_f32 v80, v74, v80
    v_add_f32 v82, v75, v82
    v_add_f32 v80, v76, v80
    v_add_f32 v82, v77, v82
    v_add_f32 v80, v78, v80
    v_add_f32 v82, v79, v82
    v_add_u32 v81, 1, v118
    v_add_u32 v83, 1, v118
    global_store_dwordx4 v123, v[80:83], s[40:41] sc1
L_dflush:
    s_branch L_end
L_comm:
    v_mov_b32 v16, 0
    v_mov_b32 v17, 0
    ds_write_b64 v6, v[16:17] offset:13952
    ds_write_b64 v6, v[16:17] offset:13960
    ds_write_b64 v6, v[16:17] offset:13968
    global_load_dword v7, v6, s[40:41] sc1
    s_min_u32 s12, s2, 159
    s_lshl_b32 s12, s12, 3
    v_mov_b32 v14, s12
    global_load_dwordx2 v[10:11], v14, s[16:17]
    global_load_dwordx2 v[12:13], v14, s[34:35]
    s_lshl_b32 s13, s4, 3
    s_add_u32 s14, s13, s5
    s_waitcnt lgkmcnt(0)
    s_barrier
    s_waitcnt vmcnt(0)
    v_add_u32 v7, 1, v7
    s_nop 0
    v_readfirstlane_b32 s46, v7
L_lw9:
    ds_read_b32 v15, v6 offset:13952
    s_waitcnt lgkmcnt(0)
    v_readfirstlane_b32 s12, v15
    s_cmp_ge_u32 s12, 8
    s_cbranch_scc1 L_lw9_d
    s_sleep 1
    s_branch L_lw9
L_lw9_d:
    ds_read_b64 v[20:21], v5 offset:5120
    ds_read_b64 v[22:23], v5 offset:5632
    ds_read_b64 v[24:25], v5 offset:6144
    ds_read_b64 v[26:27], v5 offset:6656
    ds_read_b64 v[28:29], v5 offset:7168
    ds_read_b64 v[30:31], v5 offset:7680
    ds_read_b64 v[32:33], v5 offset:8192
    ds_read_b64 v[34:35], v5 offset:8704
    s_lshl_b32 s15, s14, 10
    s_add_u32 s15, s15, 4096
    v_add_u32 v9, s15, v4
    s_waitcnt lgkmcnt(0)
    v_add_f32 v16, v20, v22
    v_add_f32 v18, v21, v23
    v_add_f32 v16, v24, v16
    v_add_f32 v18, v25, v18
    v_add_f32 v16, v26, v16
    v_add_f32 v18, v27, v18
    v_add_f32 v16, v28, v16
    v_add_f32 v18, v29, v18
    v_add_f32 v16, v30, v16
    v_add_f32 v18, v31, v18
    v_add_f32 v16, v32, v16
    v_add_f32 v18, v33, v18
    v_add_f32 v16, v34, v16
    v_add_f32 v18, v35, v18
    v_mov_b32 v17, s46
    v_mov_b32 v19, s46
    global_store_dwordx4 v9, v[16:19], s[40:41] sc1
    s_lshl_b32 s15, s13, 10
    s_add_u32 s15, s15, 4096
    v_add_u32 v9, s15, v4
    v_add_u32 v14, 0x1000, v9
    s_mov_b32 s47, 400000
L_pollq:
    global_load_dwordx4 v[20:23], v9, s[40:41] offset:0 sc1
    global_load_dwordx4 v[24:27], v9, s[40:41] offset:1024 sc1
    global_load_dwordx4 v[28:31], v9, s[40:41] offset:2048 sc1
    global_load_dwordx4 v[32:35], v9, s[40:41] offset:3072 sc1
    global_load_dwordx4 v[36:39], v14, s[40:41] offset:0 sc1
    global_load_dwordx4 v[40:43], v14, s[40:41] offset:1024 sc1
    global_load_dwordx4 v[44:47], v14, s[40:41] offset:2048 sc1
    global_load_dwordx4 v[48:51], v14, s[40:41] offset:3072 sc1
    s_waitcnt vmcnt(0)
    v_xor_b32 v15, s46, v21
    v_xor_b32 v16, s46, v23
    v_or_b32 v15, v15, v16
    v_xor_b32 v16, s46, v25
    v_or_b32 v15, v15, v16
    v_xor_b32 v16, s46, v27
    v_or_b32 v15, v15, v16
    v_xor_b32 v16, s46, v29
    v_or_b32 v15, v15, v16
    v_xor_b32 v16, s46, v31
    v_or_b32 v15, v15, v16
    v_xor_b32 v16, s46, v33
    v_or_b32 v15, v15, v16
    v_xor_b32 v16, s46, v35
    v_or_b32 v15, v15, v16
    v_xor_b32 v16, s46, v37
    v_or_b32 v15, v15, v16
    v_xor_b32 v16, s46, v39
    v_or_b32 v15, v15, v16
    v_xor_b32 v16, s46, v41
    v_or_b32 v15, v15, v16
    v_xor_b32 v16, s46, v43
    v_or_b32 v15, v15, v16
    v_xor_b32 v16, s46, v45
    v_or_b32 v15, v15, v16
    v_xor_b32 v16, s46, v47
    v_or_b32 v15, v15, v16
    v_xor_b32 v16, s46, v49
    v_or_b32 v15, v15, v16
    v_xor_b32 v16, s46, v51
    v_or_b32 v15, v15, v16
    v_cmp_ne_u32 vcc, 0, v15
    s_cbranch_vccz L_pollq_done
    s_sub_u32 s47, s47, 1
    s_cmp_eq_u32 s47, 0
    s_cbranch_scc1 L_pollq_done
    s_branch L_pollq
L_pollq_done:
    v_add_f32 v16, v20, v24
    v_add_f32 v17, v22, v26
    v_add_f32 v16, v28, v16
    v_add_f32 v17, v30, v17
    v_add_f32 v16, v32, v16
    v_add_f32 v17, v34, v17
    v_add_f32 v16, v36, v16
    v_add_f32 v17, v38, v17
    v_add_f32 v16, v40, v16
    v_add_f32 v17, v42, v17
    v_add_f32 v16, v44, v16
    v_add_f32 v17, v46, v17
    v_add_f32 v16, v48, v16
    v_add_f32 v17, v50, v17
    v_cvt_pk_bf16_f32 v16, v16, v17
    ds_write_b32 v3, v16 offset:9216
    s_waitcnt lgkmcnt(0)
    s_mov_b64 exec, 1
    ds_write_b32 v6, v8 offset:13956
    s_mov_b64 exec, -1
L_lw10:
    ds_read_b32 v15, v6 offset:13960
    s_waitcnt lgkmcnt(0)
    v_readfirstlane_b32 s12, v15
    s_cmp_ge_u32 s12, 8
    s_cbranch_scc1 L_lw10_d
    s_sleep 1
    s_branch L_lw10
L_lw10_d:
    ds_read_b64 v[20:21], v5 offset:9472
    ds_read_b64 v[22:23], v5 offset:9984
    ds_read_b64 v[24:25], v5 offset:10496
    ds_read_b64 v[26:27], v5 offset:11008
    ds_read_b64 v[28:29], v5 offset:11520
    ds_read_b64 v[30:31], v5 offset:12032
    ds_read_b64 v[32:33], v5 offset:12544
    ds_read_b64 v[34:35], v5 offset:13056
    ds_read_b64 v[40:41], v6 offset:13568
    ds_read_b64 v[42:43], v6 offset:13576
    ds_read_b64 v[44:45], v6 offset:13584
    ds_read_b64 v[46:47], v6 offset:13592
    ds_read_b64 v[48:49], v6 offset:13600
    ds_read_b64 v[50:51], v6 offset:13608
    ds_read_b64 v[52:53], v6 offset:13616
    ds_read_b64 v[54:55], v6 offset:13624
    s_waitcnt lgkmcnt(0)
    v_max3_f32 v16, v40, v42, v44
    v_max3_f32 v16, v16, v46, v48
    v_max3_f32 v16, v16, v50, v52
    v_max_f32 v16, v16, v54
    v_sub_f32 v40, v40, v16
    v_mul_f32 v40, 0x3fb8aa3b, v40
    v_exp_f32 v40, v40
    v_sub_f32 v42, v42, v16
    v_mul_f32 v42, 0x3fb8aa3b, v42
    v_exp_f32 v42, v42
    v_sub_f32 v44, v44, v16
    v_mul_f32 v44, 0x3fb8aa3b, v44
    v_exp_f32 v44, v44
    v_sub_f32 v46, v46, v16
    v_mul_f32 v46, 0x3fb8aa3b, v46
    v_exp_f32 v46, v46
    v_sub_f32 v48, v48, v16
    v_mul_f32 v48, 0x3fb8aa3b, v48
    v_exp_f32 v48, v48
    v_sub_f32 v50, v50, v16
    v_mul_f32 v50, 0x3fb8aa3b, v50
    v_exp_f32 v50, v50
    v_sub_f32 v52, v52, v16
    v_mul_f32 v52, 0x3fb8aa3b, v52
    v_exp_f32 v52, v52
    v_sub_f32 v54, v54, v16
    v_mul_f32 v54, 0x3fb8aa3b, v54
    v_exp_f32 v54, v54
    s_nop 0
    v_mul_f32 v17, v40, v41
    v_mul_f32 v60, v40, v20
    v_mul_f32 v62, v40, v21
    v_fmac_f32 v17, v42, v43
    v_fmac_f32 v60, v42, v22
    v_fmac_f32 v62, v42, v23
    v_fmac_f32 v17, v44, v45
    v_fmac_f32 v60, v44, v24
    v_fmac_f32 v62, v44, v25
    v_fmac_f32 v17, v46, v47
    v_fmac_f32 v60, v46, v26
    v_fmac_f32 v62, v46, v27
    v_fmac_f32 v17, v48, v49
    v_fmac_f32 v60, v48, v28
    v_fmac_f32 v62, v48, v29
    v_fmac_f32 v17, v50, v51
    v_fmac_f32 v60, v50, v30
    v_fmac_f32 v62, v50, v31
    v_fmac_f32 v17, v52, v53
    v_fmac_f32 v60, v52, v32
    v_fmac_f32 v62, v52, v33
    v_fmac_f32 v17, v54, v55
    v_fmac_f32 v60, v54, v34
    v_fmac_f32 v62, v54, v35
    v_mov_b32 v61, s46
    v_mov_b32 v63, s46
    s_lshl_b32 s15, s14, 11
    s_add_u32 s15, s15, 524288
    v_add_u32 v9, s15, v4
    global_store_dwordx4 v9, v[60:63], s[40:41] offset:64 sc1
    v_mov_b32 v56, v16
    v_mov_b32 v57, s46
    v_mov_b32 v58, v17
    v_mov_b32 v59, s46
    v_mov_b32 v14, s15
    s_mov_b64 exec, 1
    global_store_dwordx4 v14, v[56:59], s[40:41] sc1
    s_mov_b64 exec, -1
    s_lshl_b32 s15, s13, 11
    s_add_u32 s15, s15, 524288
    v_mov_b32 v70, s15
    v_and_b32 v9, 15, v1
    v_lshlrev_b32 v9, 3, v9
    s_lshl_b32 s12, s5, 7
    s_add_u32 s12, s12, s15
    v_add_u32 v74, s12, v9
    v_add_u32 v71, 4096, v70
    v_add_u32 v75, 4096, v74
    v_add_u32 v72, 8192, v70
    v_add_u32 v76, 8192, v74
    v_add_u32 v73, 12288, v70
    v_add_u32 v77, 12288, v74
    s_mov_b32 s47, 400000
L_pollo:
    global_load_dwordx4 v[20:23], v70, s[40:41] offset:0 sc1
    global_load_dwordx2 v[52:53], v74, s[40:41] offset:64 sc1
    global_load_dwordx4 v[24:27], v70, s[40:41] offset:2048 sc1
    global_load_dwordx2 v[54:55], v74, s[40:41] offset:2112 sc1
    global_load_dwordx4 v[28:31], v71, s[40:41] offset:0 sc1
    global_load_dwordx2 v[56:57], v75, s[40:41] offset:64 sc1
    global_load_dwordx4 v[32:35], v71, s[40:41] offset:2048 sc1
    global_load_dwordx2 v[58:59], v75, s[40:41] offset:2112 sc1
    global_load_dwordx4 v[36:39], v72, s[40:41] offset:0 sc1
    global_load_dwordx2 v[60:61], v76, s[40:41] offset:64 sc1
    global_load_dwordx4 v[40:43], v72, s[40:41] offset:2048 sc1
    global_load_dwordx2 v[62:63], v76, s[40:41] offset:2112 sc1
    global_load_dwordx4 v[44:47], v73, s[40:41] offset:0 sc1
    global_load_dwordx2 v[64:65], v77, s[40:41] offset:64 sc1
    global_load_dwordx4 v[48:51], v73, s[40:41] offset:2048 sc1
    global_load_dwordx2 v[66:67], v77, s[40:41] offset:2112 sc1
    s_waitcnt vmcnt(0)
    v_xor_b32 v16, s46, v21
    v_xor_b32 v17, s46, v23
    v_or_b32 v16, v16, v17
    v_xor_b32 v17, s46, v53
    v_or_b32 v16, v16, v17
    v_xor_b32 v17, s46, v25
    v_or_b32 v16, v16, v17
    v_xor_b32 v17, s46, v27
    v_or_b32 v16, v16, v17
    v_xor_b32 v17, s46, v55
    v_or_b32 v16, v16, v17
    v_xor_b32 v17, s46, v29
    v_or_b32 v16, v16, v17
    v_xor_b32 v17, s46, v31
    v_or_b32 v16, v16, v17
    v_xor_b32 v17, s46, v57
    v_or_b32 v16, v16, v17
    v_xor_b32 v17, s46, v33
    v_or_b32 v16, v16, v17
    v_xor_b32 v17, s46, v35
    v_or_b32 v16, v16, v17
    v_xor_b32 v17, s46, v59
    v_or_b32 v16, v16, v17
    v_xor_b32 v17, s46, v37
    v_or_b32 v16, v16, v17
    v_xor_b32 v17, s46, v39
    v_or_b32 v16, v16, v17
    v_xor_b32 v17, s46, v61
    v_or_b32 v16, v16, v17
    v_xor_b32 v17, s46, v41
    v_or_b32 v16, v16, v17
    v_xor_b32 v17, s46, v43
    v_or_b32 v16, v16, v17
    v_xor_b32 v17, s46, v63
    v_or_b32 v16, v16, v17
    v_xor_b32 v17, s46, v45
    v_or_b32 v16, v16, v17
    v_xor_b32 v17, s46, v47
    v_or_b32 v16, v16, v17
    v_xor_b32 v17, s46, v65
    v_or_b32 v16, v16, v17
    v_xor_b32 v17, s46, v49
    v_or_b32 v16, v16, v17
    v_xor_b32 v17, s46, v51
    v_or_b32 v16, v16, v17
    v_xor_b32 v17, s46, v67
    v_or_b32 v16, v16, v17
    v_cmp_ne_u32 vcc, 0, v16
    s_cbranch_vccz L_pollo_done
    s_sub_u32 s47, s47, 1
    s_cmp_eq_u32 s47, 0
    s_cbranch_scc1 L_pollo_done
    s_branch L_pollo
L_pollo_done:
    v_max3_f32 v16, v20, v24, v28
    v_max3_f32 v16, v16, v32, v36
    v_max3_f32 v16, v16, v40, v44
    v_max_f32 v16, v16, v48
    v_sub_f32 v20, v20, v16
    v_mul_f32 v20, 0x3fb8aa3b, v20
    v_exp_f32 v20, v20
    v_sub_f32 v24, v24, v16
    v_mul_f32 v24, 0x3fb8aa3b, v24
    v_exp_f32 v24, v24
    v_sub_f32 v28, v28, v16
    v_mul_f32 v28, 0x3fb8aa3b, v28
    v_exp_f32 v28, v28
    v_sub_f32 v32, v32, v16
    v_mul_f32 v32, 0x3fb8aa3b, v32
    v_exp_f32 v32, v32
    v_sub_f32 v36, v36, v16
    v_mul_f32 v36, 0x3fb8aa3b, v36
    v_exp_f32 v36, v36
    v_sub_f32 v40, v40, v16
    v_mul_f32 v40, 0x3fb8aa3b, v40
    v_exp_f32 v40, v40
    v_sub_f32 v44, v44, v16
    v_mul_f32 v44, 0x3fb8aa3b, v44
    v_exp_f32 v44, v44
    v_sub_f32 v48, v48, v16
    v_mul_f32 v48, 0x3fb8aa3b, v48
    v_exp_f32 v48, v48
    s_nop 0
    v_mul_f32 v17, v20, v22
    v_mul_f32 v18, v20, v52
    v_fmac_f32 v17, v24, v26
    v_fmac_f32 v18, v24, v54
    v_fmac_f32 v17, v28, v30
    v_fmac_f32 v18, v28, v56
    v_fmac_f32 v17, v32, v34
    v_fmac_f32 v18, v32, v58
    v_fmac_f32 v17, v36, v38
    v_fmac_f32 v18, v36, v60
    v_fmac_f32 v17, v40, v42
    v_fmac_f32 v18, v40, v62
    v_fmac_f32 v17, v44, v46
    v_fmac_f32 v18, v44, v64
    v_fmac_f32 v17, v48, v50
    v_fmac_f32 v18, v48, v66
    v_rcp_f32 v17, v17
    s_nop 0
    v_mul_f32 v18, v18, v17
    v_cvt_pk_bf16_f32 v18, v18, v18
    v_and_b32 v18, 0xffff0000, v18
    v_and_b32 v9, 15, v1
    v_lshlrev_b32 v9, 2, v9
    ds_write_b32 v9, v18 offset:13632
    s_waitcnt lgkmcnt(0)
    s_mov_b64 exec, 1
    ds_write_b32 v6, v8 offset:13964
    s_mov_b64 exec, -1
    s_cmp_ge_u32 s2, 160
    s_cbranch_scc1 L_cflush
    s_lshl_b32 s15, s2, 13
    s_add_u32 s15, s15, 1048576
    v_add_u32 v9, s15, v4
    v_add_u32 v14, 0x1000, v9
    s_mov_b32 s47, 400000
L_pollf:
    global_load_dwordx4 v[20:23], v9, s[40:41] offset:0 sc1
    global_load_dwordx4 v[24:27], v9, s[40:41] offset:1024 sc1
    global_load_dwordx4 v[28:31], v9, s[40:41] offset:2048 sc1
    global_load_dwordx4 v[32:35], v9, s[40:41] offset:3072 sc1
    global_load_dwordx4 v[36:39], v14, s[40:41] offset:0 sc1
    global_load_dwordx4 v[40:43], v14, s[40:41] offset:1024 sc1
    global_load_dwordx4 v[44:47], v14, s[40:41] offset:2048 sc1
    global_load_dwordx4 v[48:51], v14, s[40:41] offset:3072 sc1
    s_waitcnt vmcnt(0)
    v_xor_b32 v15, s46, v21
    v_xor_b32 v16, s46, v23
    v_or_b32 v15, v15, v16
    v_xor_b32 v16, s46, v25
    v_or_b32 v15, v15, v16
    v_xor_b32 v16, s46, v27
    v_or_b32 v15, v15, v16
    v_xor_b32 v16, s46, v29
    v_or_b32 v15, v15, v16
    v_xor_b32 v16, s46, v31
    v_or_b32 v15, v15, v16
    v_xor_b32 v16, s46, v33
    v_or_b32 v15, v15, v16
    v_xor_b32 v16, s46, v35
    v_or_b32 v15, v15, v16
    v_xor_b32 v16, s46, v37
    v_or_b32 v15, v15, v16
    v_xor_b32 v16, s46, v39
    v_or_b32 v15, v15, v16
    v_xor_b32 v16, s46, v41
    v_or_b32 v15, v15, v16
    v_xor_b32 v16, s46, v43
    v_or_b32 v15, v15, v16
    v_xor_b32 v16, s46, v45
    v_or_b32 v15, v15, v16
    v_xor_b32 v16, s46, v47
    v_or_b32 v15, v15, v16
    v_xor_b32 v16, s46, v49
    v_or_b32 v15, v15, v16
    v_xor_b32 v16, s46, v51
    v_or_b32 v15, v15, v16
    v_cmp_ne_u32 vcc, 0, v15
    s_cbranch_vccz L_pollf_done
    s_sub_u32 s47, s47, 1
    s_cmp_eq_u32 s47, 0
    s_cbranch_scc1 L_pollf_done
    s_branch L_pollf
L_pollf_done:
    v_add_f32 v16, v20, v24
    v_add_f32 v17, v22, v26
    v_add_f32 v16, v28, v16
    v_add_f32 v17, v30, v17
    v_add_f32 v16, v32, v16
    v_add_f32 v17, v34, v17
    v_add_f32 v16, v36, v16
    v_add_f32 v17, v38, v17
    v_add_f32 v16, v40, v16
    v_add_f32 v17, v42, v17
    v_add_f32 v16, v44, v16
    v_add_f32 v17, v46, v17
    v_add_f32 v16, v48, v16
    v_add_f32 v17, v50, v17
    s_nop 1
    v_add_f32_dpp v16, v16, v16 row_ror:2 row_mask:0xf bank_mask:0xf
    v_add_f32_dpp v17, v17, v17 row_ror:2 row_mask:0xf bank_mask:0xf
    s_nop 1
    v_add_f32_dpp v16, v16, v16 row_ror:4 row_mask:0xf bank_mask:0xf
    v_add_f32_dpp v17, v17, v17 row_ror:4 row_mask:0xf bank_mask:0xf
    s_nop 1
    v_add_f32_dpp v16, v16, v16 row_ror:8 row_mask:0xf bank_mask:0xf
    v_add_f32_dpp v17, v17, v17 row_ror:8 row_mask:0xf bank_mask:0xf
    s_nop 0
    v_readlane_b32 s48, v16, 0
    v_readlane_b32 s49, v17, 0
    v_readlane_b32 s50, v16, 1
    v_readlane_b32 s51, v17, 1
    v_readlane_b32 s52, v16, 16
    v_readlane_b32 s53, v17, 16
    v_readlane_b32 s54, v16, 17
    v_readlane_b32 s55, v17, 17
    v_readlane_b32 s56, v16, 32
    v_readlane_b32 s57, v17, 32
    v_readlane_b32 s58, v16, 33
    v_readlane_b32 s59, v17, 33
    v_readlane_b32 s60, v16, 48
    v_readlane_b32 s61, v17, 48
    v_readlane_b32 s62, v16, 49
    v_readlane_b32 s63, v17, 49
    s_nop 1
    v_mov_b32 v20, s48
    v_add_f32 v20, s52, v20
    v_add_f32 v20, s56, v20
    v_add_f32 v20, s60, v20
    v_mov_b32 v21, s49
    v_add_f32 v21, s53, v21
    v_add_f32 v21, s57, v21
    v_add_f32 v21, s61, v21
    v_mov_b32 v22, s50
    v_add_f32 v22, s54, v22
    v_add_f32 v22, s58, v22
    v_add_f32 v22, s62, v22
    v_mov_b32 v23, s51
    v_add_f32 v23, s55, v23
    v_add_f32 v23, s59, v23
    v_add_f32 v23, s63, v23
    v_lshlrev_b32 v24, 16, v10
    v_and_b32 v25, 0xffff0000, v10
    v_lshlrev_b32 v26, 16, v11
    v_and_b32 v27, 0xffff0000, v11
    v_lshlrev_b32 v28, 16, v12
    v_and_b32 v29, 0xffff0000, v12
    v_lshlrev_b32 v30, 16, v13
    v_and_b32 v31, 0xffff0000, v13
    v_add_f32 v20, v20, v28
    v_add_f32 v20, v20, v24
    v_add_f32 v21, v21, v29
    v_add_f32 v21, v21, v25
    v_add_f32 v22, v22, v30
    v_add_f32 v22, v22, v26
    v_add_f32 v23, v23, v31
    v_add_f32 v23, v23, v27
    v_cvt_pk_bf16_f32 v32, v20, v21
    v_cvt_pk_bf16_f32 v33, v22, v23
    s_lshl_b32 s12, s2, 3
    v_mov_b32 v14, s12
    s_mov_b64 exec, 1
    global_store_dwordx2 v14, v[32:33], s[36:37]
    s_cmp_lg_u32 s2, 0
    s_cbranch_scc1 L_cflush
    v_mov_b32 v7, s46
    global_store_dword v6, v7, s[40:41] sc1
L_cflush:
    s_branch L_end
L_loader:
    s_and_b32 s42, s2, 7
    s_lshr_b32 s43, s2, 3
    s_lshr_b32 s44, s43, 3
    s_lshl_b32 s44, s44, 3
    s_add_u32 s42, s42, s44
    s_and_b32 s43, s43, 7
    s_cmp_lt_u32 s42, 27
    s_cselect_b32 s45, 1, 0
    s_lshl_b32 s42, s42, 3
    s_add_u32 s42, s42, s43
    s_cmp_eq_u32 s45, 1
    s_cselect_b32 s42, s42, 0
    s_lshl_b32 s13, s4, 20
    s_lshl_b32 s14, s5, 15
    s_add_u32 s13, s13, s14
    s_add_u32 s13, s13, 786432
    v_add_u32 v10, s13, v4
    s_mov_b32 m0, 34816
    s_nop 0
    global_load_lds_dwordx4 v10, s[18:19] nt
    v_add_u32 v10, 1024, v10
    s_mov_b32 m0, 35840
    s_nop 0
    global_load_lds_dwordx4 v10, s[18:19] nt
    v_add_u32 v10, 1024, v10
    s_mov_b32 m0, 36864
    s_nop 0
    global_load_lds_dwordx4 v10, s[18:19] nt
    v_add_u32 v10, 1024, v10
    s_mov_b32 m0, 37888
    s_nop 0
    global_load_lds_dwordx4 v10, s[18:19] nt
    v_add_u32 v10, 1024, v10
    s_mov_b32 m0, 38912
    s_nop 0
    global_load_lds_dwordx4 v10, s[18:19] nt
    v_add_u32 v10, 1024, v10
    s_mov_b32 m0, 39936
    s_nop 0
    global_load_lds_dwordx4 v10, s[18:19] nt
    v_add_u32 v10, 1024, v10
    s_mov_b32 m0, 40960
    s_nop 0
    global_load_lds_dwordx4 v10, s[18:19] nt
    v_add_u32 v10, 1024, v10
    s_mov_b32 m0, 41984
    s_nop 0
    global_load_lds_dwordx4 v10, s[18:19] nt
    v_add_u32 v10, 1024, v10
    s_mov_b32 m0, 43008
    s_nop 0
    global_load_lds_dwordx4 v10, s[18:19] nt
    v_add_u32 v10, 1024, v10
    s_mov_b32 m0, 44032
    s_nop 0
    global_load_lds_dwordx4 v10, s[18:19] nt
    v_add_u32 v10, 1024, v10
    s_mov_b32 m0, 45056
    s_nop 0
    global_load_lds_dwordx4 v10, s[18:19] nt
    v_add_u32 v10, 1024, v10
    s_mov_b32 m0, 46080
    s_nop 0
    global_load_lds_dwordx4 v10, s[18:19] nt
    v_add_u32 v10, 1024, v10
    s_mov_b32 m0, 47104
    s_nop 0
    global_load_lds_dwordx4 v10, s[18:19] nt
    v_add_u32 v10, 1024, v10
    s_mov_b32 m0, 48128
    s_nop 0
    global_load_lds_dwordx4 v10, s[18:19] nt
    v_add_u32 v10, 1024, v10
    s_mov_b32 m0, 49152
    s_nop 0
    global_load_lds_dwordx4 v10, s[18:19] nt
    v_add_u32 v10, 1024, v10
    s_mov_b32 m0, 50176
    s_nop 0
    global_load_lds_dwordx4 v10, s[18:19] nt
    v_add_u32 v10, 1024, v10
    s_mov_b32 m0, 51200
    s_nop 0
    global_load_lds_dwordx4 v10, s[18:19] nt
    v_add_u32 v10, 1024, v10
    s_mov_b32 m0, 52224
    s_nop 0
    global_load_lds_dwordx4 v10, s[18:19] nt
    v_add_u32 v10, 1024, v10
    s_mov_b32 m0, 53248
    s_nop 0
    global_load_lds_dwordx4 v10, s[18:19] nt
    v_add_u32 v10, 1024, v10
    s_mov_b32 m0, 54272
    s_nop 0
    global_load_lds_dwordx4 v10, s[18:19] nt
    v_add_u32 v10, 1024, v10
    s_mov_b32 m0, 55296
    s_nop 0
    global_load_lds_dwordx4 v10, s[18:19] nt
    v_add_u32 v10, 1024, v10
    s_mov_b32 m0, 56320
    s_nop 0
    global_load_lds_dwordx4 v10, s[18:19] nt
    v_add_u32 v10, 1024, v10
    s_mov_b32 m0, 57344
    s_nop 0
    global_load_lds_dwordx4 v10, s[18:19] nt
    v_add_u32 v10, 1024, v10
    s_mov_b32 m0, 58368
    s_nop 0
    global_load_lds_dwordx4 v10, s[18:19] nt
    v_add_u32 v10, 1024, v10
    s_mov_b32 m0, 59392
    s_barrier
    s_waitcnt vmcnt(23)
    v_mov_b32 v11, 1
    ds_write_b32 v6, v11 offset:13972
    global_load_lds_dwordx4 v10, s[18:19] nt
    v_add_u32 v10, 1024, v10
    s_mov_b32 m0, 60416
    s_waitcnt vmcnt(23)
    v_mov_b32 v11, 2
    ds_write_b32 v6, v11 offset:13972
    global_load_lds_dwordx4 v10, s[18:19] nt
    v_add_u32 v10, 1024, v10
    s_mov_b32 m0, 61440
    s_waitcnt vmcnt(23)
    v_mov_b32 v11, 3
    ds_write_b32 v6, v11 offset:13972
    global_load_lds_dwordx4 v10, s[18:19] nt
    v_add_u32 v10, 1024, v10
    s_mov_b32 m0, 62464
    s_waitcnt vmcnt(23)
    v_mov_b32 v11, 4
    ds_write_b32 v6, v11 offset:13972
    global_load_lds_dwordx4 v10, s[18:19] nt
    v_add_u32 v10, 1024, v10
    s_mov_b32 m0, 63488
    s_waitcnt vmcnt(23)
    v_mov_b32 v11, 5
    ds_write_b32 v6, v11 offset:13972
    global_load_lds_dwordx4 v10, s[18:19] nt
    v_add_u32 v10, 1024, v10
    s_mov_b32 m0, 64512
    s_waitcnt vmcnt(23)
    v_mov_b32 v11, 6
    ds_write_b32 v6, v11 offset:13972
    global_load_lds_dwordx4 v10, s[18:19] nt
    v_add_u32 v10, 1024, v10
    s_mov_b32 m0, 65536
    s_waitcnt vmcnt(23)
    v_mov_b32 v11, 7
    ds_write_b32 v6, v11 offset:13972
    global_load_lds_dwordx4 v10, s[18:19] nt
    v_add_u32 v10, 1024, v10
    s_mov_b32 m0, 66560
    s_waitcnt vmcnt(23)
    v_mov_b32 v11, 8
    ds_write_b32 v6, v11 offset:13972
    global_load_lds_dwordx4 v10, s[18:19] nt
    v_add_u32 v10, s13, v4
    s_mov_b32 m0, 67584
    s_waitcnt vmcnt(23)
    v_mov_b32 v11, 9
    ds_write_b32 v6, v11 offset:13972
    global_load_lds_dwordx4 v10, s[20:21] nt
    v_add_u32 v10, 1024, v10
    s_mov_b32 m0, 68608
    s_waitcnt vmcnt(23)
    v_mov_b32 v11, 10
    ds_write_b32 v6, v11 offset:13972
    global_load_lds_dwordx4 v10, s[20:21] nt
    v_add_u32 v10, 1024, v10
    s_mov_b32 m0, 69632
    s_waitcnt vmcnt(23)
    v_mov_b32 v11, 11
    ds_write_b32 v6, v11 offset:13972
    global_load_lds_dwordx4 v10, s[20:21] nt
    v_add_u32 v10, 1024, v10
    s_mov_b32 m0, 70656
    s_waitcnt vmcnt(23)
    v_mov_b32 v11, 12
    ds_write_b32 v6, v11 offset:13972
    global_load_lds_dwordx4 v10, s[20:21] nt
    v_add_u32 v10, 1024, v10
    s_mov_b32 m0, 71680
    s_waitcnt vmcnt(23)
    v_mov_b32 v11, 13
    ds_write_b32 v6, v11 offset:13972
    global_load_lds_dwordx4 v10, s[20:21] nt
    v_add_u32 v10, 1024, v10
    s_mov_b32 m0, 72704
    s_waitcnt vmcnt(23)
    v_mov_b32 v11, 14
    ds_write_b32 v6, v11 offset:13972
    global_load_lds_dwordx4 v10, s[20:21] nt
    v_add_u32 v10, 1024, v10
    s_mov_b32 m0, 73728
    s_waitcnt vmcnt(23)
    v_mov_b32 v11, 15
    ds_write_b32 v6, v11 offset:13972
    global_load_lds_dwordx4 v10, s[20:21] nt
    v_add_u32 v10, 1024, v10
    s_mov_b32 m0, 74752
    s_waitcnt vmcnt(23)
    v_mov_b32 v11, 16
    ds_write_b32 v6, v11 offset:13972
    global_load_lds_dwordx4 v10, s[20:21] nt
    v_add_u32 v10, 1024, v10
    s_mov_b32 m0, 75776
    s_waitcnt vmcnt(23)
    v_mov_b32 v11, 17
    ds_write_b32 v6, v11 offset:13972
    global_load_lds_dwordx4 v10, s[20:21] nt
    v_add_u32 v10, 1024, v10
    s_mov_b32 m0, 76800
    s_waitcnt vmcnt(23)
    v_mov_b32 v11, 18
    ds_write_b32 v6, v11 offset:13972
    global_load_lds_dwordx4 v10, s[20:21] nt
    v_add_u32 v10, 1024, v10
    s_mov_b32 m0, 77824
    s_waitcnt vmcnt(23)
    v_mov_b32 v11, 19
    ds_write_b32 v6, v11 offset:13972
    global_load_lds_dwordx4 v10, s[20:21] nt
    v_add_u32 v10, 1024, v10
    s_mov_b32 m0, 78848
    s_waitcnt vmcnt(23)
    v_mov_b32 v11, 20
    ds_write_b32 v6, v11 offset:13972
    global_load_lds_dwordx4 v10, s[20:21] nt
    v_add_u32 v10, 1024, v10
    s_mov_b32 m0, 79872
    s_waitcnt vmcnt(23)
    v_mov_b32 v11, 21
    ds_write_b32 v6, v11 offset:13972
    global_load_lds_dwordx4 v10, s[20:21] nt
    v_add_u32 v10, 1024, v10
    s_mov_b32 m0, 80896
    s_waitcnt vmcnt(23)
    v_mov_b32 v11, 22
    ds_write_b32 v6, v11 offset:13972
    global_load_lds_dwordx4 v10, s[20:21] nt
    v_add_u32 v10, 1024, v10
    s_mov_b32 m0, 81920
    s_waitcnt vmcnt(23)
    v_mov_b32 v11, 23
    ds_write_b32 v6, v11 offset:13972
    global_load_lds_dwordx4 v10, s[20:21] nt
    v_add_u32 v10, 1024, v10
    s_mov_b32 m0, 82944
    s_waitcnt vmcnt(23)
    v_mov_b32 v11, 24
    ds_write_b32 v6, v11 offset:13972
    global_load_lds_dwordx4 v10, s[20:21] nt
    v_add_u32 v10, 1024, v10
    s_mov_b32 m0, 83968
    s_waitcnt vmcnt(23)
    v_mov_b32 v11, 25
    ds_write_b32 v6, v11 offset:13972
    global_load_lds_dwordx4 v10, s[20:21] nt
    v_add_u32 v10, 1024, v10
    s_mov_b32 m0, 84992
    s_waitcnt vmcnt(23)
    v_mov_b32 v11, 26
    ds_write_b32 v6, v11 offset:13972
    global_load_lds_dwordx4 v10, s[20:21] nt
    v_add_u32 v10, 1024, v10
    s_mov_b32 m0, 86016
    s_waitcnt vmcnt(23)
    v_mov_b32 v11, 27
    ds_write_b32 v6, v11 offset:13972
    global_load_lds_dwordx4 v10, s[20:21] nt
    v_add_u32 v10, 1024, v10
    s_mov_b32 m0, 87040
    s_waitcnt vmcnt(23)
    v_mov_b32 v11, 28
    ds_write_b32 v6, v11 offset:13972
    global_load_lds_dwordx4 v10, s[20:21] nt
    v_add_u32 v10, 1024, v10
    s_mov_b32 m0, 88064
    s_waitcnt vmcnt(23)
    v_mov_b32 v11, 29
    ds_write_b32 v6, v11 offset:13972
    global_load_lds_dwordx4 v10, s[20:21] nt
    v_add_u32 v10, 1024, v10
    s_mov_b32 m0, 89088
    s_waitcnt vmcnt(23)
    v_mov_b32 v11, 30
    ds_write_b32 v6, v11 offset:13972
    global_load_lds_dwordx4 v10, s[20:21] nt
    v_add_u32 v10, 1024, v10
    s_mov_b32 m0, 90112
    s_waitcnt vmcnt(23)
    v_mov_b32 v11, 31
    ds_write_b32 v6, v11 offset:13972
    global_load_lds_dwordx4 v10, s[20:21] nt
    v_add_u32 v10, 1024, v10
    s_mov_b32 m0, 91136
    s_waitcnt vmcnt(23)
    v_mov_b32 v11, 32
    ds_write_b32 v6, v11 offset:13972
    global_load_lds_dwordx4 v10, s[20:21] nt
    v_add_u32 v10, 1024, v10
    s_mov_b32 m0, 92160
    s_waitcnt vmcnt(23)
    v_mov_b32 v11, 33
    ds_write_b32 v6, v11 offset:13972
    global_load_lds_dwordx4 v10, s[20:21] nt
    v_add_u32 v10, 1024, v10
    s_mov_b32 m0, 93184
    s_waitcnt vmcnt(23)
    v_mov_b32 v11, 34
    ds_write_b32 v6, v11 offset:13972
    global_load_lds_dwordx4 v10, s[20:21] nt
    v_add_u32 v10, 1024, v10
    s_mov_b32 m0, 94208
    s_waitcnt vmcnt(23)
    v_mov_b32 v11, 35
    ds_write_b32 v6, v11 offset:13972
    global_load_lds_dwordx4 v10, s[20:21] nt
    v_add_u32 v10, 1024, v10
    s_mov_b32 m0, 95232
    s_waitcnt vmcnt(23)
    v_mov_b32 v11, 36
    ds_write_b32 v6, v11 offset:13972
    global_load_lds_dwordx4 v10, s[20:21] nt
    v_add_u32 v10, 1024, v10
    s_mov_b32 m0, 96256
    s_waitcnt vmcnt(23)
    v_mov_b32 v11, 37
    ds_write_b32 v6, v11 offset:13972
    global_load_lds_dwordx4 v10, s[20:21] nt
    v_add_u32 v10, 1024, v10
    s_mov_b32 m0, 97280
    s_waitcnt vmcnt(23)
    v_mov_b32 v11, 38
    ds_write_b32 v6, v11 offset:13972
    global_load_lds_dwordx4 v10, s[20:21] nt
    v_add_u32 v10, 1024, v10
    s_mov_b32 m0, 98304
    s_waitcnt vmcnt(23)
    v_mov_b32 v11, 39
    ds_write_b32 v6, v11 offset:13972
    global_load_lds_dwordx4 v10, s[20:21] nt
    v_add_u32 v10, 1024, v10
    s_mov_b32 m0, 99328
    s_waitcnt vmcnt(23)
    v_mov_b32 v11, 40
    ds_write_b32 v6, v11 offset:13972
    global_load_lds_dwordx4 v10, s[20:21] nt
    s_mov_b32 s14, 3456
    v_mul_lo_u32 v10, v1, s14
    s_lshl_b32 s14, s42, 4
    v_add_u32 v10, s14, v10
    s_mov_b32 m0, 100352
    s_waitcnt vmcnt(23)
    v_mov_b32 v11, 41
    ds_write_b32 v6, v11 offset:13972
    global_load_lds_dwordx4 v10, s[28:29] nt
    v_add_u32 v10, 221184, v10
    s_mov_b32 m0, 101376
    s_waitcnt vmcnt(23)
    v_mov_b32 v11, 42
    ds_write_b32 v6, v11 offset:13972
    global_load_lds_dwordx4 v10, s[28:29] nt
    v_add_u32 v10, 221184, v10
    s_mov_b32 m0, 102400
    s_waitcnt vmcnt(23)
    v_mov_b32 v11, 43
    ds_write_b32 v6, v11 offset:13972
    global_load_lds_dwordx4 v10, s[28:29] nt
    v_add_u32 v10, 221184, v10
    s_mov_b32 m0, 103424
    s_waitcnt vmcnt(23)
    v_mov_b32 v11, 44
    ds_write_b32 v6, v11 offset:13972
    global_load_lds_dwordx4 v10, s[28:29] nt
    v_add_u32 v10, 221184, v10
    s_mov_b32 m0, 104448
    s_waitcnt vmcnt(23)
    v_mov_b32 v11, 45
    ds_write_b32 v6, v11 offset:13972
    global_load_lds_dwordx4 v10, s[28:29] nt
    v_add_u32 v10, 221184, v10
    s_mov_b32 m0, 105472
    s_waitcnt vmcnt(23)
    v_mov_b32 v11, 46
    ds_write_b32 v6, v11 offset:13972
    global_load_lds_dwordx4 v10, s[28:29] nt
    v_add_u32 v10, 221184, v10
    s_mov_b32 m0, 106496
    s_waitcnt vmcnt(23)
    v_mov_b32 v11, 47
    ds_write_b32 v6, v11 offset:13972
    global_load_lds_dwordx4 v10, s[28:29] nt
    v_add_u32 v10, 221184, v10
    s_mov_b32 m0, 107520
    s_waitcnt vmcnt(23)
    v_mov_b32 v11, 48
    ds_write_b32 v6, v11 offset:13972
    global_load_lds_dwordx4 v10, s[28:29] nt
    v_add_u32 v10, 221184, v10
    s_mov_b32 m0, 108544
    s_waitcnt vmcnt(23)
    v_mov_b32 v11, 49
    ds_write_b32 v6, v11 offset:13972
    global_load_lds_dwordx4 v10, s[28:29] nt
    v_add_u32 v10, 221184, v10
    s_mov_b32 m0, 109568
    s_waitcnt vmcnt(23)
    v_mov_b32 v11, 50
    ds_write_b32 v6, v11 offset:13972
    global_load_lds_dwordx4 v10, s[28:29] nt
    s_mul_i32 s14, s42, 10240
    v_add_u32 v10, s14, v4
    s_mov_b32 m0, 110592
    s_waitcnt vmcnt(23)
    v_mov_b32 v11, 51
    ds_write_b32 v6, v11 offset:13972
    global_load_lds_dwordx4 v10, s[32:33] nt
    v_add_u32 v10, 1024, v10
    s_mov_b32 m0, 111616
    s_waitcnt vmcnt(23)
    v_mov_b32 v11, 52
    ds_write_b32 v6, v11 offset:13972
    global_load_lds_dwordx4 v10, s[32:33] nt
    v_add_u32 v10, 1024, v10
    s_mov_b32 m0, 112640
    s_waitcnt vmcnt(23)
    v_mov_b32 v11, 53
    ds_write_b32 v6, v11 offset:13972
    global_load_lds_dwordx4 v10, s[32:33] nt
    v_add_u32 v10, 1024, v10
    s_mov_b32 m0, 113664
    s_waitcnt vmcnt(23)
    v_mov_b32 v11, 54
    ds_write_b32 v6, v11 offset:13972
    global_load_lds_dwordx4 v10, s[32:33] nt
    v_add_u32 v10, 1024, v10
    s_mov_b32 m0, 114688
    s_waitcnt vmcnt(23)
    v_mov_b32 v11, 55
    ds_write_b32 v6, v11 offset:13972
    global_load_lds_dwordx4 v10, s[32:33] nt
    v_add_u32 v10, 1024, v10
    s_mov_b32 m0, 115712
    s_waitcnt vmcnt(23)
    v_mov_b32 v11, 56
    ds_write_b32 v6, v11 offset:13972
    global_load_lds_dwordx4 v10, s[32:33] nt
    v_add_u32 v10, 1024, v10
    s_mov_b32 m0, 116736
    s_waitcnt vmcnt(23)
    v_mov_b32 v11, 57
    ds_write_b32 v6, v11 offset:13972
    global_load_lds_dwordx4 v10, s[32:33] nt
    v_add_u32 v10, 1024, v10
    s_mov_b32 m0, 117760
    s_waitcnt vmcnt(23)
    v_mov_b32 v11, 58
    ds_write_b32 v6, v11 offset:13972
    global_load_lds_dwordx4 v10, s[32:33] nt
    v_add_u32 v10, 1024, v10
    s_mov_b32 m0, 118784
    s_waitcnt vmcnt(23)
    v_mov_b32 v11, 59
    ds_write_b32 v6, v11 offset:13972
    global_load_lds_dwordx4 v10, s[32:33] nt
    v_add_u32 v10, 1024, v10
    s_mov_b32 m0, 119808
    s_waitcnt vmcnt(23)
    v_mov_b32 v11, 60
    ds_write_b32 v6, v11 offset:13972
    global_load_lds_dwordx4 v10, s[32:33] nt
    s_lshl_b32 s14, s4, 7
    s_lshl_b32 s15, s5, 4
    s_add_u32 s14, s14, s15
    s_mul_i32 s14, s14, 1280
    v_add_u32 v10, s14, v4
    s_mov_b32 m0, 120832
    s_waitcnt vmcnt(23)
    v_mov_b32 v11, 61
    ds_write_b32 v6, v11 offset:13972
    global_load_lds_dwordx4 v10, s[24:25] nt
    v_add_u32 v10, 1024, v10
    s_mov_b32 m0, 121856
    s_waitcnt vmcnt(23)
    v_mov_b32 v11, 62
    ds_write_b32 v6, v11 offset:13972
    global_load_lds_dwordx4 v10, s[24:25] nt
    v_add_u32 v10, 1024, v10
    s_mov_b32 m0, 122880
    s_waitcnt vmcnt(23)
    v_mov_b32 v11, 63
    ds_write_b32 v6, v11 offset:13972
    global_load_lds_dwordx4 v10, s[24:25] nt
    v_add_u32 v10, 1024, v10
    s_mov_b32 m0, 123904
    s_waitcnt vmcnt(23)
    v_mov_b32 v11, 64
    ds_write_b32 v6, v11 offset:13972
    global_load_lds_dwordx4 v10, s[24:25] nt
    v_add_u32 v10, 1024, v10
    s_mov_b32 m0, 124928
    s_waitcnt vmcnt(23)
    v_mov_b32 v11, 65
    ds_write_b32 v6, v11 offset:13972
    global_load_lds_dwordx4 v10, s[24:25] nt
    v_add_u32 v10, 1024, v10
    s_mov_b32 m0, 125952
    s_waitcnt vmcnt(23)
    v_mov_b32 v11, 66
    ds_write_b32 v6, v11 offset:13972
    global_load_lds_dwordx4 v10, s[24:25] nt
    v_add_u32 v10, 1024, v10
    s_mov_b32 m0, 126976
    s_waitcnt vmcnt(23)
    v_mov_b32 v11, 67
    ds_write_b32 v6, v11 offset:13972
    global_load_lds_dwordx4 v10, s[24:25] nt
    v_add_u32 v10, 1024, v10
    s_mov_b32 m0, 128000
    s_waitcnt vmcnt(23)
    v_mov_b32 v11, 68
    ds_write_b32 v6, v11 offset:13972
    global_load_lds_dwordx4 v10, s[24:25] nt
    v_add_u32 v10, 1024, v10
    s_mov_b32 m0, 129024
    s_waitcnt vmcnt(23)
    v_mov_b32 v11, 69
    ds_write_b32 v6, v11 offset:13972
    global_load_lds_dwordx4 v10, s[24:25] nt
    v_add_u32 v10, 1024, v10
    s_mov_b32 m0, 130048
    s_waitcnt vmcnt(23)
    v_mov_b32 v11, 70
    ds_write_b32 v6, v11 offset:13972
    global_load_lds_dwordx4 v10, s[24:25] nt
    v_add_u32 v10, 1024, v10
    s_mov_b32 m0, 131072
    s_waitcnt vmcnt(23)
    v_mov_b32 v11, 71
    ds_write_b32 v6, v11 offset:13972
    global_load_lds_dwordx4 v10, s[24:25] nt
    v_add_u32 v10, 1024, v10
    s_mov_b32 m0, 132096
    s_waitcnt vmcnt(23)
    v_mov_b32 v11, 72
    ds_write_b32 v6, v11 offset:13972
    global_load_lds_dwordx4 v10, s[24:25] nt
    v_add_u32 v10, 1024, v10
    s_mov_b32 m0, 133120
    s_waitcnt vmcnt(23)
    v_mov_b32 v11, 73
    ds_write_b32 v6, v11 offset:13972
    global_load_lds_dwordx4 v10, s[24:25] nt
    v_add_u32 v10, 1024, v10
    s_mov_b32 m0, 134144
    s_waitcnt vmcnt(23)
    v_mov_b32 v11, 74
    ds_write_b32 v6, v11 offset:13972
    global_load_lds_dwordx4 v10, s[24:25] nt
    v_add_u32 v10, 1024, v10
    s_mov_b32 m0, 135168
    s_waitcnt vmcnt(23)
    v_mov_b32 v11, 75
    ds_write_b32 v6, v11 offset:13972
    global_load_lds_dwordx4 v10, s[24:25] nt
    v_add_u32 v10, 1024, v10
    s_mov_b32 m0, 136192
    s_waitcnt vmcnt(23)
    v_mov_b32 v11, 76
    ds_write_b32 v6, v11 offset:13972
    global_load_lds_dwordx4 v10, s[24:25] nt
    v_add_u32 v10, 1024, v10
    s_mov_b32 m0, 137216
    s_waitcnt vmcnt(23)
    v_mov_b32 v11, 77
    ds_write_b32 v6, v11 offset:13972
    global_load_lds_dwordx4 v10, s[24:25] nt
    v_add_u32 v10, 1024, v10
    s_mov_b32 m0, 138240
    s_waitcnt vmcnt(23)
    v_mov_b32 v11, 78
    ds_write_b32 v6, v11 offset:13972
    global_load_lds_dwordx4 v10, s[24:25] nt
    v_add_u32 v10, 1024, v10
    s_mov_b32 m0, 139264
    s_waitcnt vmcnt(23)
    v_mov_b32 v11, 79
    ds_write_b32 v6, v11 offset:13972
    global_load_lds_dwordx4 v10, s[24:25] nt
    v_add_u32 v10, 1024, v10
    s_mov_b32 m0, 140288
    s_waitcnt vmcnt(23)
    v_mov_b32 v11, 80
    ds_write_b32 v6, v11 offset:13972
    global_load_lds_dwordx4 v10, s[24:25] nt
    s_waitcnt vmcnt(23)
    v_mov_b32 v11, 81
    ds_write_b32 v6, v11 offset:13972
    s_waitcnt vmcnt(22)
    v_mov_b32 v11, 82
    ds_write_b32 v6, v11 offset:13972
    s_waitcnt vmcnt(21)
    v_mov_b32 v11, 83
    ds_write_b32 v6, v11 offset:13972
    s_waitcnt vmcnt(20)
    v_mov_b32 v11, 84
    ds_write_b32 v6, v11 offset:13972
    s_waitcnt vmcnt(19)
    v_mov_b32 v11, 85
    ds_write_b32 v6, v11 offset:13972
    s_waitcnt vmcnt(18)
    v_mov_b32 v11, 86
    ds_write_b32 v6, v11 offset:13972
    s_waitcnt vmcnt(17)
    v_mov_b32 v11, 87
    ds_write_b32 v6, v11 offset:13972
    s_waitcnt vmcnt(16)
    v_mov_b32 v11, 88
    ds_write_b32 v6, v11 offset:13972
    s_waitcnt vmcnt(15)
    v_mov_b32 v11, 89
    ds_write_b32 v6, v11 offset:13972
    s_waitcnt vmcnt(14)
    v_mov_b32 v11, 90
    ds_write_b32 v6, v11 offset:13972
    s_waitcnt vmcnt(13)
    v_mov_b32 v11, 91
    ds_write_b32 v6, v11 offset:13972
    s_waitcnt vmcnt(12)
    v_mov_b32 v11, 92
    ds_write_b32 v6, v11 offset:13972
    s_waitcnt vmcnt(11)
    v_mov_b32 v11, 93
    ds_write_b32 v6, v11 offset:13972
    s_waitcnt vmcnt(10)
    v_mov_b32 v11, 94
    ds_write_b32 v6, v11 offset:13972
    s_waitcnt vmcnt(9)
    v_mov_b32 v11, 95
    ds_write_b32 v6, v11 offset:13972
    s_waitcnt vmcnt(8)
    v_mov_b32 v11, 96
    ds_write_b32 v6, v11 offset:13972
    s_waitcnt vmcnt(7)
    v_mov_b32 v11, 97
    ds_write_b32 v6, v11 offset:13972
    s_waitcnt vmcnt(6)
    v_mov_b32 v11, 98
    ds_write_b32 v6, v11 offset:13972
    s_waitcnt vmcnt(5)
    v_mov_b32 v11, 99
    ds_write_b32 v6, v11 offset:13972
    s_waitcnt vmcnt(4)
    v_mov_b32 v11, 100
    ds_write_b32 v6, v11 offset:13972
    s_waitcnt vmcnt(3)
    v_mov_b32 v11, 101
    ds_write_b32 v6, v11 offset:13972
    s_waitcnt vmcnt(2)
    v_mov_b32 v11, 102
    ds_write_b32 v6, v11 offset:13972
    s_waitcnt vmcnt(1)
    v_mov_b32 v11, 103
    ds_write_b32 v6, v11 offset:13972
    s_waitcnt vmcnt(0)
    v_mov_b32 v11, 104
    ds_write_b32 v6, v11 offset:13972
    s_waitcnt lgkmcnt(0)
L_end:
    s_endpgm
.section .rodata,"a"
.p2align 6
.amdhsa_kernel parallel_sum__sliding_block_cached__mixer_channel_mlp__decode_kernel
  .amdhsa_next_free_vgpr 128
  .amdhsa_next_free_sgpr 100
  .amdhsa_accum_offset 128
  .amdhsa_group_segment_fixed_size 0
  .amdhsa_kernarg_size 104
  .amdhsa_user_sgpr_count 2
  .amdhsa_user_sgpr_kernarg_segment_ptr 1
  .amdhsa_system_sgpr_workgroup_id_x 1
.end_amdhsa_kernel
```
